```python
import torch

def _softmax(x, axis=-1):
    return torch.softmax(x, dim=axis)

def _gelu(x):
    return torch.nn.functional.gelu(x, approximate='tanh')

def _silu(x):
    return torch.nn.functional.silu(x)

def _sigmoid(x):
    return torch.sigmoid(x)

def _layernorm(x, axis=-1, eps=1e-05):
    m = x.mean(dim=axis, keepdim=True)
    v = x.var(dim=axis, keepdim=True, unbiased=False)
    return (x - m) / torch.sqrt(v + eps)

def _scatter_add(tgt, idx, src, axis=0):
    return tgt.clone().index_add_(axis, idx, src)

def _segment_sum(src, seg, n):
    out = torch.zeros((n,) + src.shape[1:], dtype=src.dtype)
    return out.index_add_(0, seg, src)

def _pad(x, pw):
    flat = tuple((v for pair in reversed(pw) for v in pair))
    return torch.nn.functional.pad(x, flat)
kernel_name = 'adaLN_cond__mha_block__glu_gated_bilinear__prompt'

def setup_inputs():

    _w = lambda a: (lambda t: t.to(torch.bfloat16) if t.is_floating_point() else t)(torch.as_tensor(a))

    def _A_setup():
        B, S, D, H = (1, 2048, 576, 32)
        return {'x': _w((lambda *s: torch.randn(*s, dtype=torch.bfloat16) * 0.05)(B, S, D)), 'wqkv': _w((lambda *s: torch.randn(*s, dtype=torch.bfloat16) * 0.05)(D, 3 * D)), 'wo': _w((lambda *s: torch.randn(*s, dtype=torch.bfloat16) * 0.05)(D, D))}
    _A_in = _A_setup()

    def _B_setup():
        B, S, D, F = (1, 2048, 576, 4608)
        return {'x': _w((lambda *s: torch.randn(*s, dtype=torch.bfloat16) * 0.05)(B, S, D)), 'w_gate': _w((lambda *s: torch.randn(*s, dtype=torch.bfloat16) * 0.8)(D, F) * D ** (-0.5)), 'w_up': _w((lambda *s: torch.randn(*s, dtype=torch.bfloat16) * 0.8)(D, F) * D ** (-0.5)), 'w_down': _w((lambda *s: torch.randn(*s, dtype=torch.bfloat16) * 0.8)(F, D) * F ** (-0.5))}
    _B_in = _B_setup()
    return {'A_x': _A_in['x'], 'A_wqkv': _A_in['wqkv'], 'A_wo': _A_in['wo'], 'B_x': _B_in['x'], 'B_w_gate': _B_in['w_gate'], 'B_w_up': _B_in['w_up'], 'B_w_down': _B_in['w_down'], 'c': _w((lambda *s: torch.randn(*s, dtype=torch.bfloat16) * 0.2)(1, 576) * 8.0), 'w_mod': _w((lambda *s: torch.randn(*s, dtype=torch.bfloat16) * 0.2)(576, 6 * 576) * 576 ** (-0.5) * 8.0)}

def reference(A_x, A_wqkv, A_wo, B_x, B_w_gate, B_w_up, B_w_down, c, w_mod):

    def _A_ref(x, wqkv, wo):
        B, S, D = x.shape
        H = 32
        Dh = D // H
        qkv = (lambda x, *d: x.permute(*d))((x @ wqkv).reshape(B, S, 3, H, Dh), 2, 0, 3, 1, 4)
        q, k, v = (qkv[0], qkv[1], qkv[2])
        scores = torch.einsum('bhqd,bhkd->bhqk', q, k) * Dh ** (-0.5)
        p = _softmax(scores, axis=-1)
        o = torch.einsum('bhqk,bhkd->bhqd', p, v)
        return (lambda x, *d: x.permute(*d))(o, 0, 2, 1, 3).reshape(B, S, D) @ wo

    def _B_ref(x, w_gate, w_up, w_down):
        g = torch.einsum('bsd,df->bsf', x, w_gate)
        u = torch.einsum('bsd,df->bsf', x, w_up)
        h = g * u
        return torch.einsum('bsf,fd->bsd', h, w_down)
    x = A_x
    mod = (_silu(c) @ w_mod).reshape(c.shape[0], 6, 1, -1)
    sa, ca, ga, sb, cb, gb = (mod[:, 0].clone(), mod[:, 1].clone(), mod[:, 2].clone(), mod[:, 3].clone(), mod[:, 4].clone(), mod[:, 5].clone())
    h = _layernorm(x, axis=-1) * (1 + ca) + sa
    x = x + ga * _A_ref(h, A_wqkv, A_wo)
    h = _layernorm(x, axis=-1) * (1 + cb) + sb
    x = x + gb * _B_ref(h, B_w_gate, B_w_up, B_w_down)
    return x
```

```asm
; @launch kernel=k0_kernel grid=(54,1,1) block=(256,1,1) lds=8192
; @launch kernel=ln1_kernel grid=(512,1,1) block=(256,1,1) lds=0
; @launch kernel=k1_kernel grid=(192,1,1) block=(256,1,1) lds=139264
; @launch kernel=k2_kernel grid=(256,1,1) block=(512,1,1) lds=66560
; @launch kernel=k3_kernel grid=(64,1,1) block=(256,1,1) lds=139264
; @launch kernel=ln2_kernel grid=(512,1,1) block=(256,1,1) lds=0
; @launch kernel=k4_kernel grid=(256,1,1) block=(256,1,1) lds=139264
; @launch kernel=k5_kernel grid=(256,1,1) block=(256,1,1) lds=139264
; @launch kernel=k6_kernel grid=(1152,1,1) block=(256,1,1) lds=0
.amdgcn_target "amdgcn-amd-amdhsa--gfx950"
.text
.globl k0_kernel
.p2align 8
.type k0_kernel,@function
k0_kernel:
    s_cmp_ge_u32 s2, 54
    s_cbranch_scc1 k0_end
    s_load_dwordx2 s[4:5], s[0:1], 64
    s_load_dwordx2 s[6:7], s[0:1], 56
    s_load_dwordx2 s[8:9], s[0:1], 88
    s_load_dwordx2 s[10:11], s[0:1], 0
    s_waitcnt lgkmcnt(0)
    s_cmp_ge_u32 s2, 54
    s_cbranch_scc1 k0_ln
    s_mov_b32 s12, s4
    s_mov_b32 s13, s5
    s_and_b32 s13, s13, 0xffff
    s_mov_b32 s14, 0x3cc000
    s_mov_b32 s15, 0x00020000
    s_mov_b32 s16, s6
    s_mov_b32 s17, s7
    s_and_b32 s17, s17, 0xffff
    s_mov_b32 s18, 0x480
    s_mov_b32 s19, 0x00020000
    s_mov_b32 s20, s8
    s_mov_b32 s21, s9
    s_and_b32 s21, s21, 0xffff
    s_mov_b32 s22, 0x3600
    s_mov_b32 s23, 0x00020000
    v_and_b32 v1, 7, v0
    v_lshrrev_b32 v2, 3, v0
    s_lshl_b32 s24, s2, 7
    v_lshlrev_b32 v3, 4, v1
    v_add_u32 v3, s24, v3
    s_mov_b32 s25, 6912
    v_mul_lo_u32 v4, v2, s25
    v_add_u32 v3, v3, v4
    v_lshlrev_b32 v5, 1, v2
    v_mov_b32 v10, 0
    v_mov_b32 v11, 0
    v_mov_b32 v12, 0
    v_mov_b32 v13, 0
    v_mov_b32 v14, 0
    v_mov_b32 v15, 0
    v_mov_b32 v16, 0
    v_mov_b32 v17, 0
    s_mov_b32 s26, 0
k0_lp:
    buffer_load_dwordx4 v[32:35], v3, s[12:15], 0 offen
    buffer_load_ushort v56, v5, s[16:19], 0 offen
    v_add_u32 v3, 221184, v3
    v_add_u32 v5, 64, v5
    buffer_load_dwordx4 v[36:39], v3, s[12:15], 0 offen
    buffer_load_ushort v57, v5, s[16:19], 0 offen
    v_add_u32 v3, 221184, v3
    v_add_u32 v5, 64, v5
    buffer_load_dwordx4 v[40:43], v3, s[12:15], 0 offen
    buffer_load_ushort v58, v5, s[16:19], 0 offen
    v_add_u32 v3, 221184, v3
    v_add_u32 v5, 64, v5
    buffer_load_dwordx4 v[44:47], v3, s[12:15], 0 offen
    buffer_load_ushort v59, v5, s[16:19], 0 offen
    v_add_u32 v3, 221184, v3
    v_add_u32 v5, 64, v5
    buffer_load_dwordx4 v[48:51], v3, s[12:15], 0 offen
    buffer_load_ushort v60, v5, s[16:19], 0 offen
    v_add_u32 v3, 221184, v3
    v_add_u32 v5, 64, v5
    buffer_load_dwordx4 v[52:55], v3, s[12:15], 0 offen
    buffer_load_ushort v61, v5, s[16:19], 0 offen
    v_add_u32 v3, 221184, v3
    v_add_u32 v5, 64, v5
    s_waitcnt vmcnt(0)
    v_lshlrev_b32 v24, 16, v56
    v_mul_f32 v25, 0xbfb8aa3b, v24
    v_exp_f32 v25, v25
    s_nop 0
    v_add_f32 v25, 1.0, v25
    v_rcp_f32 v25, v25
    s_nop 0
    v_mul_f32 v24, v24, v25
    v_lshlrev_b32 v26, 16, v32
    v_and_b32 v27, 0xffff0000, v32
    v_fmac_f32 v10, v24, v26
    v_fmac_f32 v11, v24, v27
    v_lshlrev_b32 v26, 16, v33
    v_and_b32 v27, 0xffff0000, v33
    v_fmac_f32 v12, v24, v26
    v_fmac_f32 v13, v24, v27
    v_lshlrev_b32 v26, 16, v34
    v_and_b32 v27, 0xffff0000, v34
    v_fmac_f32 v14, v24, v26
    v_fmac_f32 v15, v24, v27
    v_lshlrev_b32 v26, 16, v35
    v_and_b32 v27, 0xffff0000, v35
    v_fmac_f32 v16, v24, v26
    v_fmac_f32 v17, v24, v27
    v_lshlrev_b32 v24, 16, v57
    v_mul_f32 v25, 0xbfb8aa3b, v24
    v_exp_f32 v25, v25
    s_nop 0
    v_add_f32 v25, 1.0, v25
    v_rcp_f32 v25, v25
    s_nop 0
    v_mul_f32 v24, v24, v25
    v_lshlrev_b32 v26, 16, v36
    v_and_b32 v27, 0xffff0000, v36
    v_fmac_f32 v10, v24, v26
    v_fmac_f32 v11, v24, v27
    v_lshlrev_b32 v26, 16, v37
    v_and_b32 v27, 0xffff0000, v37
    v_fmac_f32 v12, v24, v26
    v_fmac_f32 v13, v24, v27
    v_lshlrev_b32 v26, 16, v38
    v_and_b32 v27, 0xffff0000, v38
    v_fmac_f32 v14, v24, v26
    v_fmac_f32 v15, v24, v27
    v_lshlrev_b32 v26, 16, v39
    v_and_b32 v27, 0xffff0000, v39
    v_fmac_f32 v16, v24, v26
    v_fmac_f32 v17, v24, v27
    v_lshlrev_b32 v24, 16, v58
    v_mul_f32 v25, 0xbfb8aa3b, v24
    v_exp_f32 v25, v25
    s_nop 0
    v_add_f32 v25, 1.0, v25
    v_rcp_f32 v25, v25
    s_nop 0
    v_mul_f32 v24, v24, v25
    v_lshlrev_b32 v26, 16, v40
    v_and_b32 v27, 0xffff0000, v40
    v_fmac_f32 v10, v24, v26
    v_fmac_f32 v11, v24, v27
    v_lshlrev_b32 v26, 16, v41
    v_and_b32 v27, 0xffff0000, v41
    v_fmac_f32 v12, v24, v26
    v_fmac_f32 v13, v24, v27
    v_lshlrev_b32 v26, 16, v42
    v_and_b32 v27, 0xffff0000, v42
    v_fmac_f32 v14, v24, v26
    v_fmac_f32 v15, v24, v27
    v_lshlrev_b32 v26, 16, v43
    v_and_b32 v27, 0xffff0000, v43
    v_fmac_f32 v16, v24, v26
    v_fmac_f32 v17, v24, v27
    v_lshlrev_b32 v24, 16, v59
    v_mul_f32 v25, 0xbfb8aa3b, v24
    v_exp_f32 v25, v25
    s_nop 0
    v_add_f32 v25, 1.0, v25
    v_rcp_f32 v25, v25
    s_nop 0
    v_mul_f32 v24, v24, v25
    v_lshlrev_b32 v26, 16, v44
    v_and_b32 v27, 0xffff0000, v44
    v_fmac_f32 v10, v24, v26
    v_fmac_f32 v11, v24, v27
    v_lshlrev_b32 v26, 16, v45
    v_and_b32 v27, 0xffff0000, v45
    v_fmac_f32 v12, v24, v26
    v_fmac_f32 v13, v24, v27
    v_lshlrev_b32 v26, 16, v46
    v_and_b32 v27, 0xffff0000, v46
    v_fmac_f32 v14, v24, v26
    v_fmac_f32 v15, v24, v27
    v_lshlrev_b32 v26, 16, v47
    v_and_b32 v27, 0xffff0000, v47
    v_fmac_f32 v16, v24, v26
    v_fmac_f32 v17, v24, v27
    v_lshlrev_b32 v24, 16, v60
    v_mul_f32 v25, 0xbfb8aa3b, v24
    v_exp_f32 v25, v25
    s_nop 0
    v_add_f32 v25, 1.0, v25
    v_rcp_f32 v25, v25
    s_nop 0
    v_mul_f32 v24, v24, v25
    v_lshlrev_b32 v26, 16, v48
    v_and_b32 v27, 0xffff0000, v48
    v_fmac_f32 v10, v24, v26
    v_fmac_f32 v11, v24, v27
    v_lshlrev_b32 v26, 16, v49
    v_and_b32 v27, 0xffff0000, v49
    v_fmac_f32 v12, v24, v26
    v_fmac_f32 v13, v24, v27
    v_lshlrev_b32 v26, 16, v50
    v_and_b32 v27, 0xffff0000, v50
    v_fmac_f32 v14, v24, v26
    v_fmac_f32 v15, v24, v27
    v_lshlrev_b32 v26, 16, v51
    v_and_b32 v27, 0xffff0000, v51
    v_fmac_f32 v16, v24, v26
    v_fmac_f32 v17, v24, v27
    v_lshlrev_b32 v24, 16, v61
    v_mul_f32 v25, 0xbfb8aa3b, v24
    v_exp_f32 v25, v25
    s_nop 0
    v_add_f32 v25, 1.0, v25
    v_rcp_f32 v25, v25
    s_nop 0
    v_mul_f32 v24, v24, v25
    v_lshlrev_b32 v26, 16, v52
    v_and_b32 v27, 0xffff0000, v52
    v_fmac_f32 v10, v24, v26
    v_fmac_f32 v11, v24, v27
    v_lshlrev_b32 v26, 16, v53
    v_and_b32 v27, 0xffff0000, v53
    v_fmac_f32 v12, v24, v26
    v_fmac_f32 v13, v24, v27
    v_lshlrev_b32 v26, 16, v54
    v_and_b32 v27, 0xffff0000, v54
    v_fmac_f32 v14, v24, v26
    v_fmac_f32 v15, v24, v27
    v_lshlrev_b32 v26, 16, v55
    v_and_b32 v27, 0xffff0000, v55
    v_fmac_f32 v16, v24, v26
    v_fmac_f32 v17, v24, v27
    s_add_u32 s26, s26, 1
    s_cmp_lt_u32 s26, 3
    s_cbranch_scc1 k0_lp
    v_lshlrev_b32 v6, 8, v2
    v_lshlrev_b32 v7, 5, v1
    v_add_u32 v6, v6, v7
    ds_write_b128 v6, v[10:13]
    ds_write_b128 v6, v[14:17] offset:16
    s_waitcnt lgkmcnt(0)
    s_barrier
    v_cmp_gt_u32 vcc, 64, v0
    s_and_saveexec_b64 s[26:27], vcc
    s_cbranch_execz k0_end
    v_lshlrev_b32 v6, 2, v0
    v_mov_b32 v10, 0
    ds_read_b32 v12, v6 offset:0
    ds_read_b32 v13, v6 offset:256
    ds_read_b32 v14, v6 offset:512
    ds_read_b32 v15, v6 offset:768
    ds_read_b32 v16, v6 offset:1024
    ds_read_b32 v17, v6 offset:1280
    ds_read_b32 v18, v6 offset:1536
    ds_read_b32 v19, v6 offset:1792
    ds_read_b32 v20, v6 offset:2048
    ds_read_b32 v21, v6 offset:2304
    ds_read_b32 v22, v6 offset:2560
    ds_read_b32 v23, v6 offset:2816
    ds_read_b32 v24, v6 offset:3072
    ds_read_b32 v25, v6 offset:3328
    ds_read_b32 v26, v6 offset:3584
    ds_read_b32 v27, v6 offset:3840
    ds_read_b32 v28, v6 offset:4096
    ds_read_b32 v29, v6 offset:4352
    ds_read_b32 v30, v6 offset:4608
    ds_read_b32 v31, v6 offset:4864
    ds_read_b32 v32, v6 offset:5120
    ds_read_b32 v33, v6 offset:5376
    ds_read_b32 v34, v6 offset:5632
    ds_read_b32 v35, v6 offset:5888
    ds_read_b32 v36, v6 offset:6144
    ds_read_b32 v37, v6 offset:6400
    ds_read_b32 v38, v6 offset:6656
    ds_read_b32 v39, v6 offset:6912
    ds_read_b32 v40, v6 offset:7168
    ds_read_b32 v41, v6 offset:7424
    ds_read_b32 v42, v6 offset:7680
    ds_read_b32 v43, v6 offset:7936
    s_waitcnt lgkmcnt(0)
    v_add_f32 v10, v10, v12
    v_add_f32 v10, v10, v13
    v_add_f32 v10, v10, v14
    v_add_f32 v10, v10, v15
    v_add_f32 v10, v10, v16
    v_add_f32 v10, v10, v17
    v_add_f32 v10, v10, v18
    v_add_f32 v10, v10, v19
    v_add_f32 v10, v10, v20
    v_add_f32 v10, v10, v21
    v_add_f32 v10, v10, v22
    v_add_f32 v10, v10, v23
    v_add_f32 v10, v10, v24
    v_add_f32 v10, v10, v25
    v_add_f32 v10, v10, v26
    v_add_f32 v10, v10, v27
    v_add_f32 v10, v10, v28
    v_add_f32 v10, v10, v29
    v_add_f32 v10, v10, v30
    v_add_f32 v10, v10, v31
    v_add_f32 v10, v10, v32
    v_add_f32 v10, v10, v33
    v_add_f32 v10, v10, v34
    v_add_f32 v10, v10, v35
    v_add_f32 v10, v10, v36
    v_add_f32 v10, v10, v37
    v_add_f32 v10, v10, v38
    v_add_f32 v10, v10, v39
    v_add_f32 v10, v10, v40
    v_add_f32 v10, v10, v41
    v_add_f32 v10, v10, v42
    v_add_f32 v10, v10, v43
    s_lshl_b32 s24, s2, 8
    v_add_u32 v6, s24, v6
    buffer_store_dword v10, v6, s[20:23], 0 offen
    s_branch k0_end
k0_ln:
k0_end:
    s_endpgm

.globl ln1_kernel
.p2align 8
.type ln1_kernel,@function
ln1_kernel:
    s_cmp_ge_u32 s2, 512
    s_cbranch_scc1 ln1_kernel_end
    s_load_dwordx2 s[4:5], s[0:1], 0
    s_load_dwordx2 s[8:9], s[0:1], 88
    s_waitcnt lgkmcnt(0)
    s_mov_b32 s12, s4
    s_mov_b32 s13, s5
    s_and_b32 s13, s13, 0xffff
    s_mov_b32 s14, 0x240000
    s_mov_b32 s15, 0x00020000
    s_add_u32 s16, s8, 0x3c00000
    s_addc_u32 s17, s9, 0
    s_and_b32 s17, s17, 0xffff
    s_mov_b32 s18, 0x240000
    s_mov_b32 s19, 0x00020000
    s_mov_b32 s20, s8
    s_mov_b32 s21, s9
    s_and_b32 s21, s21, 0xffff
    s_mov_b32 s22, 0x4000
    s_mov_b32 s23, 0x00020000
    v_lshrrev_b32 v1, 6, v0
    v_and_b32 v3, 63, v0
    s_lshl_b32 s24, s2, 2
    v_add_u32 v4, s24, v1
    s_mov_b32 s25, 1152
    v_mul_lo_u32 v5, v4, s25
    v_lshlrev_b32 v6, 4, v3
    v_add_u32 v5, v5, v6
    v_lshlrev_b32 v7, 5, v3
    v_mov_b32 v24, 0
    v_mov_b32 v25, 0
    v_mov_b32 v26, 0
    v_mov_b32 v27, 0
    buffer_load_dwordx4 v[20:23], v5, s[12:15], 0 offen
    v_add_u32 v8, 2304, v7
    v_add_u32 v9, 0, v7
    buffer_load_dwordx4 v[32:35], v8, s[20:23], 0 offen
    buffer_load_dwordx4 v[36:39], v8, s[20:23], 0 offen offset:16
    buffer_load_dwordx4 v[40:43], v9, s[20:23], 0 offen
    buffer_load_dwordx4 v[44:47], v9, s[20:23], 0 offen offset:16
    v_cmp_gt_u32 vcc, 8, v3
    s_and_saveexec_b64 s[26:27], vcc
    buffer_load_dwordx4 v[24:27], v5, s[12:15], 0 offen offset:1024
    buffer_load_dwordx4 v[48:51], v8, s[20:23], 0 offen offset:2048
    buffer_load_dwordx4 v[52:55], v8, s[20:23], 0 offen offset:2064
    buffer_load_dwordx4 v[56:59], v9, s[20:23], 0 offen offset:2048
    buffer_load_dwordx4 v[60:63], v9, s[20:23], 0 offen offset:2064
    s_mov_b64 exec, s[26:27]
    s_waitcnt vmcnt(0)
    v_mov_b32 v10, 0
    v_mov_b32 v11, 0
    v_lshlrev_b32 v12, 16, v20
    v_and_b32 v13, 0xffff0000, v20
    v_add_f32 v10, v10, v12
    v_fmac_f32 v11, v12, v12
    v_add_f32 v10, v10, v13
    v_fmac_f32 v11, v13, v13
    v_lshlrev_b32 v12, 16, v21
    v_and_b32 v13, 0xffff0000, v21
    v_add_f32 v10, v10, v12
    v_fmac_f32 v11, v12, v12
    v_add_f32 v10, v10, v13
    v_fmac_f32 v11, v13, v13
    v_lshlrev_b32 v12, 16, v22
    v_and_b32 v13, 0xffff0000, v22
    v_add_f32 v10, v10, v12
    v_fmac_f32 v11, v12, v12
    v_add_f32 v10, v10, v13
    v_fmac_f32 v11, v13, v13
    v_lshlrev_b32 v12, 16, v23
    v_and_b32 v13, 0xffff0000, v23
    v_add_f32 v10, v10, v12
    v_fmac_f32 v11, v12, v12
    v_add_f32 v10, v10, v13
    v_fmac_f32 v11, v13, v13
    v_lshlrev_b32 v12, 16, v24
    v_and_b32 v13, 0xffff0000, v24
    v_add_f32 v10, v10, v12
    v_fmac_f32 v11, v12, v12
    v_add_f32 v10, v10, v13
    v_fmac_f32 v11, v13, v13
    v_lshlrev_b32 v12, 16, v25
    v_and_b32 v13, 0xffff0000, v25
    v_add_f32 v10, v10, v12
    v_fmac_f32 v11, v12, v12
    v_add_f32 v10, v10, v13
    v_fmac_f32 v11, v13, v13
    v_lshlrev_b32 v12, 16, v26
    v_and_b32 v13, 0xffff0000, v26
    v_add_f32 v10, v10, v12
    v_fmac_f32 v11, v12, v12
    v_add_f32 v10, v10, v13
    v_fmac_f32 v11, v13, v13
    v_lshlrev_b32 v12, 16, v27
    v_and_b32 v13, 0xffff0000, v27
    v_add_f32 v10, v10, v12
    v_fmac_f32 v11, v12, v12
    v_add_f32 v10, v10, v13
    v_fmac_f32 v11, v13, v13
    v_mov_b32 v31, v3
    v_xor_b32 v30, 1, v31
    v_lshlrev_b32 v30, 2, v30
    ds_bpermute_b32 v14, v30, v10
    ds_bpermute_b32 v15, v30, v11
    s_waitcnt lgkmcnt(0)
    v_add_f32 v10, v10, v14
    v_add_f32 v11, v11, v15
    v_xor_b32 v30, 2, v31
    v_lshlrev_b32 v30, 2, v30
    ds_bpermute_b32 v14, v30, v10
    ds_bpermute_b32 v15, v30, v11
    s_waitcnt lgkmcnt(0)
    v_add_f32 v10, v10, v14
    v_add_f32 v11, v11, v15
    v_xor_b32 v30, 4, v31
    v_lshlrev_b32 v30, 2, v30
    ds_bpermute_b32 v14, v30, v10
    ds_bpermute_b32 v15, v30, v11
    s_waitcnt lgkmcnt(0)
    v_add_f32 v10, v10, v14
    v_add_f32 v11, v11, v15
    v_xor_b32 v30, 8, v31
    v_lshlrev_b32 v30, 2, v30
    ds_bpermute_b32 v14, v30, v10
    ds_bpermute_b32 v15, v30, v11
    s_waitcnt lgkmcnt(0)
    v_add_f32 v10, v10, v14
    v_add_f32 v11, v11, v15
    v_xor_b32 v30, 16, v31
    v_lshlrev_b32 v30, 2, v30
    ds_bpermute_b32 v14, v30, v10
    ds_bpermute_b32 v15, v30, v11
    s_waitcnt lgkmcnt(0)
    v_add_f32 v10, v10, v14
    v_add_f32 v11, v11, v15
    v_xor_b32 v30, 32, v31
    v_lshlrev_b32 v30, 2, v30
    ds_bpermute_b32 v14, v30, v10
    ds_bpermute_b32 v15, v30, v11
    s_waitcnt lgkmcnt(0)
    v_add_f32 v10, v10, v14
    v_add_f32 v11, v11, v15
    v_mul_f32 v10, 0.001736111111111111, v10
    v_mul_f32 v11, 0.001736111111111111, v11
    v_fma_f32 v11, -v10, v10, v11
    v_add_f32 v11, 0x3727c5ac, v11
    v_rsq_f32 v11, v11
    s_nop 0
    v_mul_f32 v10, v10, v11
    v_sub_f32 v10, 0, v10
    v_lshlrev_b32 v12, 16, v20
    v_and_b32 v13, 0xffff0000, v20
    v_fma_f32 v12, v12, v11, v10
    v_fma_f32 v13, v13, v11, v10
    v_add_f32 v14, 1.0, v32
    v_add_f32 v15, 1.0, v33
    v_fma_f32 v12, v12, v14, v40
    v_fma_f32 v13, v13, v15, v41
    v_cvt_pk_bf16_f32 v20, v12, v13
    v_lshlrev_b32 v12, 16, v21
    v_and_b32 v13, 0xffff0000, v21
    v_fma_f32 v12, v12, v11, v10
    v_fma_f32 v13, v13, v11, v10
    v_add_f32 v14, 1.0, v34
    v_add_f32 v15, 1.0, v35
    v_fma_f32 v12, v12, v14, v42
    v_fma_f32 v13, v13, v15, v43
    v_cvt_pk_bf16_f32 v21, v12, v13
    v_lshlrev_b32 v12, 16, v22
    v_and_b32 v13, 0xffff0000, v22
    v_fma_f32 v12, v12, v11, v10
    v_fma_f32 v13, v13, v11, v10
    v_add_f32 v14, 1.0, v36
    v_add_f32 v15, 1.0, v37
    v_fma_f32 v12, v12, v14, v44
    v_fma_f32 v13, v13, v15, v45
    v_cvt_pk_bf16_f32 v22, v12, v13
    v_lshlrev_b32 v12, 16, v23
    v_and_b32 v13, 0xffff0000, v23
    v_fma_f32 v12, v12, v11, v10
    v_fma_f32 v13, v13, v11, v10
    v_add_f32 v14, 1.0, v38
    v_add_f32 v15, 1.0, v39
    v_fma_f32 v12, v12, v14, v46
    v_fma_f32 v13, v13, v15, v47
    v_cvt_pk_bf16_f32 v23, v12, v13
    v_lshlrev_b32 v12, 16, v24
    v_and_b32 v13, 0xffff0000, v24
    v_fma_f32 v12, v12, v11, v10
    v_fma_f32 v13, v13, v11, v10
    v_add_f32 v14, 1.0, v48
    v_add_f32 v15, 1.0, v49
    v_fma_f32 v12, v12, v14, v56
    v_fma_f32 v13, v13, v15, v57
    v_cvt_pk_bf16_f32 v24, v12, v13
    v_lshlrev_b32 v12, 16, v25
    v_and_b32 v13, 0xffff0000, v25
    v_fma_f32 v12, v12, v11, v10
    v_fma_f32 v13, v13, v11, v10
    v_add_f32 v14, 1.0, v50
    v_add_f32 v15, 1.0, v51
    v_fma_f32 v12, v12, v14, v58
    v_fma_f32 v13, v13, v15, v59
    v_cvt_pk_bf16_f32 v25, v12, v13
    v_lshlrev_b32 v12, 16, v26
    v_and_b32 v13, 0xffff0000, v26
    v_fma_f32 v12, v12, v11, v10
    v_fma_f32 v13, v13, v11, v10
    v_add_f32 v14, 1.0, v52
    v_add_f32 v15, 1.0, v53
    v_fma_f32 v12, v12, v14, v60
    v_fma_f32 v13, v13, v15, v61
    v_cvt_pk_bf16_f32 v26, v12, v13
    v_lshlrev_b32 v12, 16, v27
    v_and_b32 v13, 0xffff0000, v27
    v_fma_f32 v12, v12, v11, v10
    v_fma_f32 v13, v13, v11, v10
    v_add_f32 v14, 1.0, v54
    v_add_f32 v15, 1.0, v55
    v_fma_f32 v12, v12, v14, v62
    v_fma_f32 v13, v13, v15, v63
    v_cvt_pk_bf16_f32 v27, v12, v13
    buffer_store_dwordx4 v[20:23], v5, s[16:19], 0 offen
    v_cmp_gt_u32 vcc, 8, v3
    s_and_saveexec_b64 s[26:27], vcc
    buffer_store_dwordx4 v[24:27], v5, s[16:19], 0 offen offset:1024
ln1_kernel_end:
    s_endpgm

.globl k1_kernel
.p2align 8
.type k1_kernel,@function
k1_kernel:
    s_cmp_ge_u32 s2, 192
    s_cbranch_scc1 k1_end
    s_load_dwordx2 s[4:5], s[0:1], 0
    s_load_dwordx2 s[6:7], s[0:1], 8
    s_load_dwordx2 s[8:9], s[0:1], 88
    s_waitcnt lgkmcnt(0)
    s_add_u32 s40, s8, 0x3c00000
    s_addc_u32 s41, s9, 0
    s_and_b32 s41, s41, 0xffff
    s_mov_b32 s42, 0x240000
    s_mov_b32 s43, 0x00020000
    s_mov_b32 s44, s6
    s_mov_b32 s45, s7
    s_and_b32 s45, s45, 0xffff
    s_mov_b32 s46, 0x1e6000
    s_mov_b32 s47, 0x00020000
    s_mov_b32 s52, s8
    s_mov_b32 s53, s9
    s_and_b32 s53, s53, 0xffff
    s_mov_b32 s54, 0x10000
    s_mov_b32 s55, 0x00020000
    s_add_u32 s56, s8, 0x100000
    s_addc_u32 s57, s9, 0
    s_and_b32 s57, s57, 0xffff
    s_mov_b32 s58, 0xc00000
    s_mov_b32 s59, 0x00020000
    s_mul_i32 s10, s2, 5462
    s_lshr_b32 s10, s10, 16
    s_mul_i32 s11, s10, 12
    s_sub_u32 s11, s2, s11
    s_lshl_b32 s20, s10, 7
    s_mul_i32 s21, s11, 144
    s_mov_b32 s22, 0
    v_and_b32 v1, 63, v0
    v_lshrrev_b32 v2, 6, v0
    s_nop 0
    v_readfirstlane_b32 s23, v2
    s_mov_b32 s24, 0
    s_mov_b32 s25, s23
    s_mov_b32 s26, 1152
    s_mul_i32 s27, s23, 32
    v_lshrrev_b32 v3, 3, v1
    v_add_u32 v3, 0, v3
    v_add_u32 v3, s27, v3
    v_lshrrev_b32 v4, 1, v3
    v_and_b32 v4, 7, v4
    v_and_b32 v5, 7, v1
    v_xor_b32 v4, v4, v5
    v_add_u32 v3, s20, v3
    v_mul_lo_u32 v8, v3, s26
    v_lshlrev_b32 v4, 4, v4
    v_add_u32 v8, v8, v4
    v_lshrrev_b32 v3, 3, v1
    v_add_u32 v3, 8, v3
    v_add_u32 v3, s27, v3
    v_lshrrev_b32 v4, 1, v3
    v_and_b32 v4, 7, v4
    v_and_b32 v5, 7, v1
    v_xor_b32 v4, v4, v5
    v_add_u32 v3, s20, v3
    v_mul_lo_u32 v9, v3, s26
    v_lshlrev_b32 v4, 4, v4
    v_add_u32 v9, v9, v4
    v_lshrrev_b32 v3, 3, v1
    v_add_u32 v3, 16, v3
    v_add_u32 v3, s27, v3
    v_lshrrev_b32 v4, 1, v3
    v_and_b32 v4, 7, v4
    v_and_b32 v5, 7, v1
    v_xor_b32 v4, v4, v5
    v_add_u32 v3, s20, v3
    v_mul_lo_u32 v10, v3, s26
    v_lshlrev_b32 v4, 4, v4
    v_add_u32 v10, v10, v4
    v_lshrrev_b32 v3, 3, v1
    v_add_u32 v3, 24, v3
    v_add_u32 v3, s27, v3
    v_lshrrev_b32 v4, 1, v3
    v_and_b32 v4, 7, v4
    v_and_b32 v5, 7, v1
    v_xor_b32 v4, v4, v5
    v_add_u32 v3, s20, v3
    v_mul_lo_u32 v11, v3, s26
    v_lshlrev_b32 v4, 4, v4
    v_add_u32 v11, v11, v4
    s_mov_b32 s27, 3456
    s_lshl_b32 s28, s21, 1
    s_add_u32 s29, s23, 0
    s_min_u32 s29, s29, 17
    s_lshl_b32 s29, s29, 6
    v_add_u32 v5, s29, v1
    s_mov_b32 s29, 3641
    v_mul_lo_u32 v6, v5, s29
    v_lshrrev_b32 v6, 16, v6
    v_mul_u32_u24 v7, 18, v6
    v_sub_u32 v7, v5, v7
    v_and_b32 v3, 32, v6
    v_bfe_u32 v4, v6, 4, 1
    v_lshlrev_b32 v4, 2, v4
    v_add_u32 v3, v3, v4
    v_bfe_u32 v4, v6, 2, 2
    v_lshlrev_b32 v4, 3, v4
    v_add_u32 v3, v3, v4
    v_and_b32 v4, 3, v6
    v_add_u32 v3, v3, v4
    v_mul_lo_u32 v17, v3, s27
    v_lshlrev_b32 v7, 4, v7
    v_add_u32 v17, v17, v7
    v_add_u32 v17, s28, v17
    s_add_u32 s29, s23, 4
    s_min_u32 s29, s29, 17
    s_lshl_b32 s29, s29, 6
    v_add_u32 v5, s29, v1
    s_mov_b32 s29, 3641
    v_mul_lo_u32 v6, v5, s29
    v_lshrrev_b32 v6, 16, v6
    v_mul_u32_u24 v7, 18, v6
    v_sub_u32 v7, v5, v7
    v_and_b32 v3, 32, v6
    v_bfe_u32 v4, v6, 4, 1
    v_lshlrev_b32 v4, 2, v4
    v_add_u32 v3, v3, v4
    v_bfe_u32 v4, v6, 2, 2
    v_lshlrev_b32 v4, 3, v4
    v_add_u32 v3, v3, v4
    v_and_b32 v4, 3, v6
    v_add_u32 v3, v3, v4
    v_mul_lo_u32 v18, v3, s27
    v_lshlrev_b32 v7, 4, v7
    v_add_u32 v18, v18, v7
    v_add_u32 v18, s28, v18
    s_add_u32 s29, s23, 8
    s_min_u32 s29, s29, 17
    s_lshl_b32 s29, s29, 6
    v_add_u32 v5, s29, v1
    s_mov_b32 s29, 3641
    v_mul_lo_u32 v6, v5, s29
    v_lshrrev_b32 v6, 16, v6
    v_mul_u32_u24 v7, 18, v6
    v_sub_u32 v7, v5, v7
    v_and_b32 v3, 32, v6
    v_bfe_u32 v4, v6, 4, 1
    v_lshlrev_b32 v4, 2, v4
    v_add_u32 v3, v3, v4
    v_bfe_u32 v4, v6, 2, 2
    v_lshlrev_b32 v4, 3, v4
    v_add_u32 v3, v3, v4
    v_and_b32 v4, 3, v6
    v_add_u32 v3, v3, v4
    v_mul_lo_u32 v19, v3, s27
    v_lshlrev_b32 v7, 4, v7
    v_add_u32 v19, v19, v7
    v_add_u32 v19, s28, v19
    s_add_u32 s29, s23, 12
    s_min_u32 s29, s29, 17
    s_lshl_b32 s29, s29, 6
    v_add_u32 v5, s29, v1
    s_mov_b32 s29, 3641
    v_mul_lo_u32 v6, v5, s29
    v_lshrrev_b32 v6, 16, v6
    v_mul_u32_u24 v7, 18, v6
    v_sub_u32 v7, v5, v7
    v_and_b32 v3, 32, v6
    v_bfe_u32 v4, v6, 4, 1
    v_lshlrev_b32 v4, 2, v4
    v_add_u32 v3, v3, v4
    v_bfe_u32 v4, v6, 2, 2
    v_lshlrev_b32 v4, 3, v4
    v_add_u32 v3, v3, v4
    v_and_b32 v4, 3, v6
    v_add_u32 v3, v3, v4
    v_mul_lo_u32 v20, v3, s27
    v_lshlrev_b32 v7, 4, v7
    v_add_u32 v20, v20, v7
    v_add_u32 v20, s28, v20
    s_add_u32 s29, s23, 16
    s_min_u32 s29, s29, 17
    s_lshl_b32 s29, s29, 6
    v_add_u32 v5, s29, v1
    s_mov_b32 s29, 3641
    v_mul_lo_u32 v6, v5, s29
    v_lshrrev_b32 v6, 16, v6
    v_mul_u32_u24 v7, 18, v6
    v_sub_u32 v7, v5, v7
    v_and_b32 v3, 32, v6
    v_bfe_u32 v4, v6, 4, 1
    v_lshlrev_b32 v4, 2, v4
    v_add_u32 v3, v3, v4
    v_bfe_u32 v4, v6, 2, 2
    v_lshlrev_b32 v4, 3, v4
    v_add_u32 v3, v3, v4
    v_and_b32 v4, 3, v6
    v_add_u32 v3, v3, v4
    v_mul_lo_u32 v21, v3, s27
    v_lshlrev_b32 v7, 4, v7
    v_add_u32 v21, v21, v7
    v_add_u32 v21, s28, v21
    v_and_b32 v5, 15, v1
    v_lshrrev_b32 v6, 4, v1
    v_lshrrev_b32 v7, 1, v5
    v_xor_b32 v7, v7, v6
    s_lshl_b32 s26, s25, 12
    v_lshlrev_b32 v27, 7, v5
    v_add_u32 v27, s26, v27
    v_xor_b32 v28, 4, v7
    v_lshlrev_b32 v28, 4, v28
    v_add_u32 v28, v27, v28
    v_lshlrev_b32 v7, 4, v7
    v_add_u32 v27, v27, v7
    v_and_b32 v5, 15, v1
    v_lshrrev_b32 v6, 4, v1
    v_lshrrev_b32 v7, 2, v5
    v_lshlrev_b32 v31, 2, v6
    v_add_u32 v31, v31, v7
    v_mul_u32_u24 v31, 288, v31
    v_and_b32 v5, 3, v5
    v_lshlrev_b32 v5, 3, v5
    v_add_u32 v31, v31, v5
    v_add_u32 v31, 16384, v31
    s_mov_b32 s70, 0
    s_mov_b32 s71, 0
    s_mov_b32 s73, 0
    s_min_u32 s72, s70, 8
    s_lshl_b32 s30, s72, 6
    s_add_u32 s30, s30, s22
    s_mul_i32 s31, s30, 3456
    s_lshl_b32 s30, s30, 1
    s_mul_i32 s32, s23, 4096
    s_add_u32 s32, s32, s71
    s_add_u32 m0, s32, 0
    s_nop 0
    buffer_load_dwordx4 v8, s[40:43], s30 offen lds
    s_add_u32 m0, s32, 1024
    s_nop 0
    buffer_load_dwordx4 v9, s[40:43], s30 offen lds
    s_add_u32 m0, s32, 2048
    s_nop 0
    buffer_load_dwordx4 v10, s[40:43], s30 offen lds
    s_add_u32 m0, s32, 3072
    s_nop 0
    buffer_load_dwordx4 v11, s[40:43], s30 offen lds
    s_add_u32 s33, s23, 0
    s_min_u32 s33, s33, 17
    s_lshl_b32 s33, s33, 10
    s_add_u32 s33, s33, s71
    s_add_u32 m0, s33, 16384
    s_nop 0
    buffer_load_dwordx4 v17, s[44:47], s31 offen lds
    s_add_u32 s33, s23, 4
    s_min_u32 s33, s33, 17
    s_lshl_b32 s33, s33, 10
    s_add_u32 s33, s33, s71
    s_add_u32 m0, s33, 16384
    s_nop 0
    buffer_load_dwordx4 v18, s[44:47], s31 offen lds
    s_add_u32 s33, s23, 8
    s_min_u32 s33, s33, 17
    s_lshl_b32 s33, s33, 10
    s_add_u32 s33, s33, s71
    s_add_u32 m0, s33, 16384
    s_nop 0
    buffer_load_dwordx4 v19, s[44:47], s31 offen lds
    s_add_u32 s33, s23, 12
    s_min_u32 s33, s33, 17
    s_lshl_b32 s33, s33, 10
    s_add_u32 s33, s33, s71
    s_add_u32 m0, s33, 16384
    s_nop 0
    buffer_load_dwordx4 v20, s[44:47], s31 offen lds
    s_add_u32 s33, s23, 16
    s_min_u32 s33, s33, 17
    s_lshl_b32 s33, s33, 10
    s_add_u32 s33, s33, s71
    s_add_u32 m0, s33, 16384
    s_nop 0
    buffer_load_dwordx4 v21, s[44:47], s31 offen lds
    s_add_u32 s70, s70, 1
    s_add_u32 s71, s71, 34816
    s_cmp_ge_u32 s71, 139264
    s_cselect_b32 s71, 0, s71
    s_min_u32 s72, s70, 8
    s_lshl_b32 s30, s72, 6
    s_add_u32 s30, s30, s22
    s_mul_i32 s31, s30, 3456
    s_lshl_b32 s30, s30, 1
    s_mul_i32 s32, s23, 4096
    s_add_u32 s32, s32, s71
    s_add_u32 m0, s32, 0
    s_nop 0
    buffer_load_dwordx4 v8, s[40:43], s30 offen lds
    s_add_u32 m0, s32, 1024
    s_nop 0
    buffer_load_dwordx4 v9, s[40:43], s30 offen lds
    s_add_u32 m0, s32, 2048
    s_nop 0
    buffer_load_dwordx4 v10, s[40:43], s30 offen lds
    s_add_u32 m0, s32, 3072
    s_nop 0
    buffer_load_dwordx4 v11, s[40:43], s30 offen lds
    s_add_u32 s33, s23, 0
    s_min_u32 s33, s33, 17
    s_lshl_b32 s33, s33, 10
    s_add_u32 s33, s33, s71
    s_add_u32 m0, s33, 16384
    s_nop 0
    buffer_load_dwordx4 v17, s[44:47], s31 offen lds
    s_add_u32 s33, s23, 4
    s_min_u32 s33, s33, 17
    s_lshl_b32 s33, s33, 10
    s_add_u32 s33, s33, s71
    s_add_u32 m0, s33, 16384
    s_nop 0
    buffer_load_dwordx4 v18, s[44:47], s31 offen lds
    s_add_u32 s33, s23, 8
    s_min_u32 s33, s33, 17
    s_lshl_b32 s33, s33, 10
    s_add_u32 s33, s33, s71
    s_add_u32 m0, s33, 16384
    s_nop 0
    buffer_load_dwordx4 v19, s[44:47], s31 offen lds
    s_add_u32 s33, s23, 12
    s_min_u32 s33, s33, 17
    s_lshl_b32 s33, s33, 10
    s_add_u32 s33, s33, s71
    s_add_u32 m0, s33, 16384
    s_nop 0
    buffer_load_dwordx4 v20, s[44:47], s31 offen lds
    s_add_u32 s33, s23, 16
    s_min_u32 s33, s33, 17
    s_lshl_b32 s33, s33, 10
    s_add_u32 s33, s33, s71
    s_add_u32 m0, s33, 16384
    s_nop 0
    buffer_load_dwordx4 v21, s[44:47], s31 offen lds
    s_add_u32 s70, s70, 1
    s_add_u32 s71, s71, 34816
    s_cmp_ge_u32 s71, 139264
    s_cselect_b32 s71, 0, s71
    s_min_u32 s72, s70, 8
    s_lshl_b32 s30, s72, 6
    s_add_u32 s30, s30, s22
    s_mul_i32 s31, s30, 3456
    s_lshl_b32 s30, s30, 1
    s_mul_i32 s32, s23, 4096
    s_add_u32 s32, s32, s71
    s_add_u32 m0, s32, 0
    s_nop 0
    buffer_load_dwordx4 v8, s[40:43], s30 offen lds
    s_add_u32 m0, s32, 1024
    s_nop 0
    buffer_load_dwordx4 v9, s[40:43], s30 offen lds
    s_add_u32 m0, s32, 2048
    s_nop 0
    buffer_load_dwordx4 v10, s[40:43], s30 offen lds
    s_add_u32 m0, s32, 3072
    s_nop 0
    buffer_load_dwordx4 v11, s[40:43], s30 offen lds
    s_add_u32 s33, s23, 0
    s_min_u32 s33, s33, 17
    s_lshl_b32 s33, s33, 10
    s_add_u32 s33, s33, s71
    s_add_u32 m0, s33, 16384
    s_nop 0
    buffer_load_dwordx4 v17, s[44:47], s31 offen lds
    s_add_u32 s33, s23, 4
    s_min_u32 s33, s33, 17
    s_lshl_b32 s33, s33, 10
    s_add_u32 s33, s33, s71
    s_add_u32 m0, s33, 16384
    s_nop 0
    buffer_load_dwordx4 v18, s[44:47], s31 offen lds
    s_add_u32 s33, s23, 8
    s_min_u32 s33, s33, 17
    s_lshl_b32 s33, s33, 10
    s_add_u32 s33, s33, s71
    s_add_u32 m0, s33, 16384
    s_nop 0
    buffer_load_dwordx4 v19, s[44:47], s31 offen lds
    s_add_u32 s33, s23, 12
    s_min_u32 s33, s33, 17
    s_lshl_b32 s33, s33, 10
    s_add_u32 s33, s33, s71
    s_add_u32 m0, s33, 16384
    s_nop 0
    buffer_load_dwordx4 v20, s[44:47], s31 offen lds
    s_add_u32 s33, s23, 16
    s_min_u32 s33, s33, 17
    s_lshl_b32 s33, s33, 10
    s_add_u32 s33, s33, s71
    s_add_u32 m0, s33, 16384
    s_nop 0
    buffer_load_dwordx4 v21, s[44:47], s31 offen lds
    s_add_u32 s70, s70, 1
    s_add_u32 s71, s71, 34816
    s_cmp_ge_u32 s71, 139264
    s_cselect_b32 s71, 0, s71
    v_mov_b32 v96, 0
    v_mov_b32 v97, 0
    v_mov_b32 v98, 0
    v_mov_b32 v99, 0
    v_mov_b32 v100, 0
    v_mov_b32 v101, 0
    v_mov_b32 v102, 0
    v_mov_b32 v103, 0
    v_mov_b32 v104, 0
    v_mov_b32 v105, 0
    v_mov_b32 v106, 0
    v_mov_b32 v107, 0
    v_mov_b32 v108, 0
    v_mov_b32 v109, 0
    v_mov_b32 v110, 0
    v_mov_b32 v111, 0
    v_mov_b32 v112, 0
    v_mov_b32 v113, 0
    v_mov_b32 v114, 0
    v_mov_b32 v115, 0
    v_mov_b32 v116, 0
    v_mov_b32 v117, 0
    v_mov_b32 v118, 0
    v_mov_b32 v119, 0
    v_mov_b32 v120, 0
    v_mov_b32 v121, 0
    v_mov_b32 v122, 0
    v_mov_b32 v123, 0
    v_mov_b32 v124, 0
    v_mov_b32 v125, 0
    v_mov_b32 v126, 0
    v_mov_b32 v127, 0
    v_mov_b32 v128, 0
    v_mov_b32 v129, 0
    v_mov_b32 v130, 0
    v_mov_b32 v131, 0
    v_mov_b32 v132, 0
    v_mov_b32 v133, 0
    v_mov_b32 v134, 0
    v_mov_b32 v135, 0
    v_mov_b32 v136, 0
    v_mov_b32 v137, 0
    v_mov_b32 v138, 0
    v_mov_b32 v139, 0
    v_mov_b32 v140, 0
    v_mov_b32 v141, 0
    v_mov_b32 v142, 0
    v_mov_b32 v143, 0
    v_mov_b32 v144, 0
    v_mov_b32 v145, 0
    v_mov_b32 v146, 0
    v_mov_b32 v147, 0
    v_mov_b32 v148, 0
    v_mov_b32 v149, 0
    v_mov_b32 v150, 0
    v_mov_b32 v151, 0
    v_mov_b32 v152, 0
    v_mov_b32 v153, 0
    v_mov_b32 v154, 0
    v_mov_b32 v155, 0
    v_mov_b32 v156, 0
    v_mov_b32 v157, 0
    v_mov_b32 v158, 0
    v_mov_b32 v159, 0
    v_mov_b32 v160, 0
    v_mov_b32 v161, 0
    v_mov_b32 v162, 0
    v_mov_b32 v163, 0
    v_mov_b32 v164, 0
    v_mov_b32 v165, 0
    v_mov_b32 v166, 0
    v_mov_b32 v167, 0
    s_mov_b32 s74, 0
kloop_300001:
    s_waitcnt vmcnt(18) lgkmcnt(0)
    s_barrier
    v_add_u32 v33, s73, v27
    v_add_u32 v34, s73, v28
    v_add_u32 v35, s73, v31
    ds_read_b128 v[40:43], v33 offset:0
    ds_read_b128 v[44:47], v33 offset:2048
    ds_read_b64_tr_b16 v[56:57], v35 offset:0
    ds_read_b64_tr_b16 v[58:59], v35 offset:4608
    ds_read_b64_tr_b16 v[60:61], v35 offset:32
    ds_read_b64_tr_b16 v[62:63], v35 offset:4640
    ds_read_b64_tr_b16 v[64:65], v35 offset:64
    ds_read_b64_tr_b16 v[66:67], v35 offset:4672
    s_waitcnt lgkmcnt(4)
    v_mfma_f32_16x16x32_bf16 v[96:99], v[56:59], v[40:43], v[96:99]
    v_mfma_f32_16x16x32_bf16 v[100:103], v[56:59], v[44:47], v[100:103]
    ds_read_b64_tr_b16 v[68:69], v35 offset:96
    ds_read_b64_tr_b16 v[70:71], v35 offset:4704
    s_min_u32 s72, s70, 8
    s_lshl_b32 s30, s72, 6
    s_add_u32 s30, s30, s22
    s_mul_i32 s31, s30, 3456
    s_lshl_b32 s30, s30, 1
    s_mul_i32 s32, s23, 4096
    s_add_u32 s32, s32, s71
    s_add_u32 m0, s32, 0
    s_nop 0
    buffer_load_dwordx4 v8, s[40:43], s30 offen lds
    s_waitcnt lgkmcnt(4)
    v_mfma_f32_16x16x32_bf16 v[104:107], v[60:63], v[40:43], v[104:107]
    v_mfma_f32_16x16x32_bf16 v[108:111], v[60:63], v[44:47], v[108:111]
    ds_read_b64_tr_b16 v[56:57], v35 offset:128
    ds_read_b64_tr_b16 v[58:59], v35 offset:4736
    s_add_u32 m0, s32, 1024
    s_nop 0
    buffer_load_dwordx4 v9, s[40:43], s30 offen lds
    s_waitcnt lgkmcnt(4)
    v_mfma_f32_16x16x32_bf16 v[112:115], v[64:67], v[40:43], v[112:115]
    v_mfma_f32_16x16x32_bf16 v[116:119], v[64:67], v[44:47], v[116:119]
    ds_read_b64_tr_b16 v[60:61], v35 offset:160
    ds_read_b64_tr_b16 v[62:63], v35 offset:4768
    s_add_u32 m0, s32, 2048
    s_nop 0
    buffer_load_dwordx4 v10, s[40:43], s30 offen lds
    s_waitcnt lgkmcnt(4)
    v_mfma_f32_16x16x32_bf16 v[120:123], v[68:71], v[40:43], v[120:123]
    v_mfma_f32_16x16x32_bf16 v[124:127], v[68:71], v[44:47], v[124:127]
    ds_read_b64_tr_b16 v[64:65], v35 offset:192
    ds_read_b64_tr_b16 v[66:67], v35 offset:4800
    s_add_u32 m0, s32, 3072
    s_nop 0
    buffer_load_dwordx4 v11, s[40:43], s30 offen lds
    s_waitcnt lgkmcnt(4)
    v_mfma_f32_16x16x32_bf16 v[128:131], v[56:59], v[40:43], v[128:131]
    v_mfma_f32_16x16x32_bf16 v[132:135], v[56:59], v[44:47], v[132:135]
    ds_read_b64_tr_b16 v[68:69], v35 offset:224
    ds_read_b64_tr_b16 v[70:71], v35 offset:4832
    s_add_u32 s33, s23, 0
    s_min_u32 s33, s33, 17
    s_lshl_b32 s33, s33, 10
    s_add_u32 s33, s33, s71
    s_add_u32 m0, s33, 16384
    s_nop 0
    buffer_load_dwordx4 v17, s[44:47], s31 offen lds
    s_waitcnt lgkmcnt(4)
    v_mfma_f32_16x16x32_bf16 v[136:139], v[60:63], v[40:43], v[136:139]
    v_mfma_f32_16x16x32_bf16 v[140:143], v[60:63], v[44:47], v[140:143]
    ds_read_b64_tr_b16 v[56:57], v35 offset:256
    ds_read_b64_tr_b16 v[58:59], v35 offset:4864
    s_add_u32 s33, s23, 4
    s_min_u32 s33, s33, 17
    s_lshl_b32 s33, s33, 10
    s_add_u32 s33, s33, s71
    s_add_u32 m0, s33, 16384
    s_nop 0
    buffer_load_dwordx4 v18, s[44:47], s31 offen lds
    s_waitcnt lgkmcnt(4)
    v_mfma_f32_16x16x32_bf16 v[144:147], v[64:67], v[40:43], v[144:147]
    v_mfma_f32_16x16x32_bf16 v[148:151], v[64:67], v[44:47], v[148:151]
    s_add_u32 s33, s23, 8
    s_min_u32 s33, s33, 17
    s_lshl_b32 s33, s33, 10
    s_add_u32 s33, s33, s71
    s_add_u32 m0, s33, 16384
    s_nop 0
    buffer_load_dwordx4 v19, s[44:47], s31 offen lds
    s_waitcnt lgkmcnt(2)
    v_mfma_f32_16x16x32_bf16 v[152:155], v[68:71], v[40:43], v[152:155]
    v_mfma_f32_16x16x32_bf16 v[156:159], v[68:71], v[44:47], v[156:159]
    s_add_u32 s33, s23, 12
    s_min_u32 s33, s33, 17
    s_lshl_b32 s33, s33, 10
    s_add_u32 s33, s33, s71
    s_add_u32 m0, s33, 16384
    s_nop 0
    buffer_load_dwordx4 v20, s[44:47], s31 offen lds
    s_waitcnt lgkmcnt(0)
    v_mfma_f32_16x16x32_bf16 v[160:163], v[56:59], v[40:43], v[160:163]
    v_mfma_f32_16x16x32_bf16 v[164:167], v[56:59], v[44:47], v[164:167]
    s_add_u32 s33, s23, 16
    s_min_u32 s33, s33, 17
    s_lshl_b32 s33, s33, 10
    s_add_u32 s33, s33, s71
    s_add_u32 m0, s33, 16384
    s_nop 0
    buffer_load_dwordx4 v21, s[44:47], s31 offen lds
    ds_read_b128 v[40:43], v34 offset:0
    ds_read_b128 v[44:47], v34 offset:2048
    ds_read_b64_tr_b16 v[56:57], v35 offset:9216
    ds_read_b64_tr_b16 v[58:59], v35 offset:13824
    ds_read_b64_tr_b16 v[60:61], v35 offset:9248
    ds_read_b64_tr_b16 v[62:63], v35 offset:13856
    ds_read_b64_tr_b16 v[64:65], v35 offset:9280
    ds_read_b64_tr_b16 v[66:67], v35 offset:13888
    s_waitcnt lgkmcnt(4)
    v_mfma_f32_16x16x32_bf16 v[96:99], v[56:59], v[40:43], v[96:99]
    v_mfma_f32_16x16x32_bf16 v[100:103], v[56:59], v[44:47], v[100:103]
    ds_read_b64_tr_b16 v[68:69], v35 offset:9312
    ds_read_b64_tr_b16 v[70:71], v35 offset:13920
    s_waitcnt lgkmcnt(4)
    v_mfma_f32_16x16x32_bf16 v[104:107], v[60:63], v[40:43], v[104:107]
    v_mfma_f32_16x16x32_bf16 v[108:111], v[60:63], v[44:47], v[108:111]
    ds_read_b64_tr_b16 v[56:57], v35 offset:9344
    ds_read_b64_tr_b16 v[58:59], v35 offset:13952
    s_waitcnt lgkmcnt(4)
    v_mfma_f32_16x16x32_bf16 v[112:115], v[64:67], v[40:43], v[112:115]
    v_mfma_f32_16x16x32_bf16 v[116:119], v[64:67], v[44:47], v[116:119]
    ds_read_b64_tr_b16 v[60:61], v35 offset:9376
    ds_read_b64_tr_b16 v[62:63], v35 offset:13984
    s_waitcnt lgkmcnt(4)
    v_mfma_f32_16x16x32_bf16 v[120:123], v[68:71], v[40:43], v[120:123]
    v_mfma_f32_16x16x32_bf16 v[124:127], v[68:71], v[44:47], v[124:127]
    ds_read_b64_tr_b16 v[64:65], v35 offset:9408
    ds_read_b64_tr_b16 v[66:67], v35 offset:14016
    s_waitcnt lgkmcnt(4)
    v_mfma_f32_16x16x32_bf16 v[128:131], v[56:59], v[40:43], v[128:131]
    v_mfma_f32_16x16x32_bf16 v[132:135], v[56:59], v[44:47], v[132:135]
    ds_read_b64_tr_b16 v[68:69], v35 offset:9440
    ds_read_b64_tr_b16 v[70:71], v35 offset:14048
    s_waitcnt lgkmcnt(4)
    v_mfma_f32_16x16x32_bf16 v[136:139], v[60:63], v[40:43], v[136:139]
    v_mfma_f32_16x16x32_bf16 v[140:143], v[60:63], v[44:47], v[140:143]
    ds_read_b64_tr_b16 v[56:57], v35 offset:9472
    ds_read_b64_tr_b16 v[58:59], v35 offset:14080
    s_waitcnt lgkmcnt(4)
    v_mfma_f32_16x16x32_bf16 v[144:147], v[64:67], v[40:43], v[144:147]
    v_mfma_f32_16x16x32_bf16 v[148:151], v[64:67], v[44:47], v[148:151]
    s_waitcnt lgkmcnt(2)
    v_mfma_f32_16x16x32_bf16 v[152:155], v[68:71], v[40:43], v[152:155]
    v_mfma_f32_16x16x32_bf16 v[156:159], v[68:71], v[44:47], v[156:159]
    s_waitcnt lgkmcnt(0)
    v_mfma_f32_16x16x32_bf16 v[160:163], v[56:59], v[40:43], v[160:163]
    v_mfma_f32_16x16x32_bf16 v[164:167], v[56:59], v[44:47], v[164:167]
    s_add_u32 s70, s70, 1
    s_add_u32 s71, s71, 34816
    s_cmp_ge_u32 s71, 139264
    s_cselect_b32 s71, 0, s71
    s_add_u32 s73, s73, 34816
    s_cmp_ge_u32 s73, 139264
    s_cselect_b32 s73, 0, s73
    s_add_u32 s74, s74, 1
    s_cmp_lt_u32 s74, 9
    s_cbranch_scc1 kloop_300001
    s_waitcnt vmcnt(0)
    s_nop 7
    s_nop 7
    s_barrier
    v_and_b32 v5, 15, v1
    s_lshl_b32 s26, s25, 5
    v_add_u32 v5, s26, v5
    v_mul_u32_u24 v5, 304, v5
    v_lshrrev_b32 v6, 4, v1
    v_lshlrev_b32 v6, 3, v6
    v_add_u32 v5, v5, v6
    v_cvt_pk_bf16_f32 v44, v96, v97
    v_cvt_pk_bf16_f32 v45, v98, v99
    ds_write_b64 v5, v[44:45] offset:0
    v_cvt_pk_bf16_f32 v44, v100, v101
    v_cvt_pk_bf16_f32 v45, v102, v103
    ds_write_b64 v5, v[44:45] offset:4864
    v_cvt_pk_bf16_f32 v44, v104, v105
    v_cvt_pk_bf16_f32 v45, v106, v107
    ds_write_b64 v5, v[44:45] offset:32
    v_cvt_pk_bf16_f32 v44, v108, v109
    v_cvt_pk_bf16_f32 v45, v110, v111
    ds_write_b64 v5, v[44:45] offset:4896
    v_cvt_pk_bf16_f32 v44, v112, v113
    v_cvt_pk_bf16_f32 v45, v114, v115
    ds_write_b64 v5, v[44:45] offset:64
    v_cvt_pk_bf16_f32 v44, v116, v117
    v_cvt_pk_bf16_f32 v45, v118, v119
    ds_write_b64 v5, v[44:45] offset:4928
    v_cvt_pk_bf16_f32 v44, v120, v121
    v_cvt_pk_bf16_f32 v45, v122, v123
    ds_write_b64 v5, v[44:45] offset:96
    v_cvt_pk_bf16_f32 v44, v124, v125
    v_cvt_pk_bf16_f32 v45, v126, v127
    ds_write_b64 v5, v[44:45] offset:4960
    v_cvt_pk_bf16_f32 v44, v128, v129
    v_cvt_pk_bf16_f32 v45, v130, v131
    ds_write_b64 v5, v[44:45] offset:128
    v_cvt_pk_bf16_f32 v44, v132, v133
    v_cvt_pk_bf16_f32 v45, v134, v135
    ds_write_b64 v5, v[44:45] offset:4992
    v_cvt_pk_bf16_f32 v44, v136, v137
    v_cvt_pk_bf16_f32 v45, v138, v139
    ds_write_b64 v5, v[44:45] offset:160
    v_cvt_pk_bf16_f32 v44, v140, v141
    v_cvt_pk_bf16_f32 v45, v142, v143
    ds_write_b64 v5, v[44:45] offset:5024
    v_cvt_pk_bf16_f32 v44, v144, v145
    v_cvt_pk_bf16_f32 v45, v146, v147
    ds_write_b64 v5, v[44:45] offset:192
    v_cvt_pk_bf16_f32 v44, v148, v149
    v_cvt_pk_bf16_f32 v45, v150, v151
    ds_write_b64 v5, v[44:45] offset:5056
    v_cvt_pk_bf16_f32 v44, v152, v153
    v_cvt_pk_bf16_f32 v45, v154, v155
    ds_write_b64 v5, v[44:45] offset:224
    v_cvt_pk_bf16_f32 v44, v156, v157
    v_cvt_pk_bf16_f32 v45, v158, v159
    ds_write_b64 v5, v[44:45] offset:5088
    v_cvt_pk_bf16_f32 v44, v160, v161
    v_cvt_pk_bf16_f32 v45, v162, v163
    ds_write_b64 v5, v[44:45] offset:256
    v_cvt_pk_bf16_f32 v44, v164, v165
    v_cvt_pk_bf16_f32 v45, v166, v167
    ds_write_b64 v5, v[44:45] offset:5120
    s_waitcnt lgkmcnt(0)
ep_300002:
    s_barrier
    s_cmp_ge_u32 s11, 8
    s_cbranch_scc1 k1_vout
    s_lshr_b32 s12, s11, 2
    s_and_b32 s13, s11, 3
    s_lshl_b32 s13, s13, 3
    s_lshl_b32 s12, s12, 22
    s_mov_b32 s14, 0
k1_ql:
    v_add_u32 v5, s14, v0
    v_lshrrev_b32 v6, 5, v5
    v_bfe_u32 v7, v5, 2, 3
    v_and_b32 v8, 3, v5
    v_mul_u32_u24 v9, 304, v6
    v_mul_u32_u24 v10, 36, v7
    v_add_u32 v9, v9, v10
    v_lshlrev_b32 v10, 4, v8
    v_add_u32 v9, v9, v10
    ds_read_b32 v40, v9 offset:0
    ds_read_b32 v41, v9 offset:4
    ds_read_b32 v42, v9 offset:8
    ds_read_b32 v43, v9 offset:12
    s_waitcnt lgkmcnt(0)
    v_cmp_gt_u32 vcc, 2, v8
    v_cndmask_b32 v41, 0, v41, vcc
    v_cndmask_b32 v42, 0, v42, vcc
    v_cndmask_b32 v43, 0, v43, vcc
    v_cmp_gt_u32 vcc, 3, v8
    v_cndmask_b32 v40, 0, v40, vcc
    v_add_u32 v10, s13, v7
    v_lshlrev_b32 v10, 11, v10
    v_add_u32 v10, v10, v6
    v_add_u32 v10, s20, v10
    v_lshlrev_b32 v10, 6, v10
    v_lshlrev_b32 v11, 4, v8
    v_add_u32 v10, v10, v11
    v_add_u32 v10, s12, v10
    buffer_store_dwordx4 v[40:43], v10, s[56:59], 0 offen
    s_add_u32 s14, s14, 256
    s_cmp_lt_u32 s14, 4096
    s_cbranch_scc1 k1_ql
    s_branch k1_end
k1_vout:
    s_and_b32 s13, s11, 3
    s_lshl_b32 s13, s13, 3
    s_mov_b32 s14, 0
k1_vl:
    v_add_u32 v5, s14, v0
    v_lshrrev_b32 v6, 9, v5
    v_bfe_u32 v7, v5, 4, 5
    v_and_b32 v8, 15, v5
    v_lshrrev_b32 v9, 1, v8
    v_lshlrev_b32 v9, 4, v9
    v_and_b32 v10, 1, v8
    v_lshlrev_b32 v10, 2, v10
    v_add_u32 v9, v9, v10
    v_mul_u32_u24 v9, 304, v9
    v_min_u32 v12, 17, v7
    v_mul_u32_u24 v10, 18, v6
    v_add_u32 v10, v10, v12
    v_lshlrev_b32 v10, 1, v10
    v_add_u32 v9, v9, v10
    ds_read_u16 v40, v9 offset:0
    ds_read_u16 v41, v9 offset:304
    ds_read_u16 v42, v9 offset:608
    ds_read_u16 v43, v9 offset:912
    ds_read_u16 v44, v9 offset:2432
    ds_read_u16 v45, v9 offset:2736
    ds_read_u16 v46, v9 offset:3040
    ds_read_u16 v47, v9 offset:3344
    s_waitcnt lgkmcnt(0)
    v_lshlrev_b32 v41, 16, v41
    v_or_b32 v48, v40, v41
    v_lshlrev_b32 v43, 16, v43
    v_or_b32 v49, v42, v43
    v_lshlrev_b32 v45, 16, v45
    v_or_b32 v50, v44, v45
    v_lshlrev_b32 v47, 16, v47
    v_or_b32 v51, v46, v47
    v_cmp_eq_u32 vcc, 18, v7
    v_mov_b32 v13, 0x3f803f80
    v_cndmask_b32 v13, 0, v13, vcc
    v_cmp_gt_u32 vcc, 18, v7
    v_cndmask_b32 v48, v13, v48, vcc
    v_cndmask_b32 v49, v13, v49, vcc
    v_cndmask_b32 v50, v13, v50, vcc
    v_cndmask_b32 v51, v13, v51, vcc
    v_add_u32 v10, s13, v6
    v_lshlrev_b32 v10, 5, v10
    v_add_u32 v10, v10, v7
    v_lshlrev_b32 v10, 11, v10
    v_lshlrev_b32 v11, 3, v8
    v_add_u32 v10, v10, v11
    v_add_u32 v10, s20, v10
    v_lshlrev_b32 v10, 1, v10
    v_add_u32 v10, 0x800000, v10
    buffer_store_dwordx4 v[48:51], v10, s[56:59], 0 offen
    s_add_u32 s14, s14, 256
    s_cmp_lt_u32 s14, 4096
    s_cbranch_scc1 k1_vl
k1_end:
    s_endpgm

.globl k2_kernel
.p2align 8
.type k2_kernel,@function
k2_kernel:
    s_cmp_ge_u32 s2, 256
    s_cbranch_scc1 k2_end
    s_load_dwordx2 s[8:9], s[0:1], 88
    s_waitcnt lgkmcnt(0)
    s_add_u32 s12, s8, 0x100000
    s_addc_u32 s13, s9, 0
    s_and_b32 s13, s13, 0xffff
    s_mov_b32 s14, 0xc00000
    s_mov_b32 s15, 0x00020000
    s_add_u32 s16, s8, 0xd00000
    s_addc_u32 s17, s9, 0
    s_and_b32 s17, s17, 0xffff
    s_mov_b32 s18, 0x240000
    s_mov_b32 s19, 0x00020000
    s_lshr_b32 s20, s2, 3
    s_and_b32 s21, s2, 7
    v_and_b32 v1, 63, v0
    v_lshrrev_b32 v2, 6, v0
    v_and_b32 v3, 31, v1
    v_lshrrev_b32 v4, 5, v1
    v_lshlrev_b32 v5, 5, v2
    v_add_u32 v5, v5, v3
    s_lshl_b32 s22, s21, 8
    v_add_u32 v5, s22, v5
    v_mov_b32 v60, v5
    s_lshl_b32 s23, s20, 11
    v_add_u32 v5, s23, v5
    v_lshlrev_b32 v5, 6, v5
    v_lshlrev_b32 v6, 4, v4
    v_add_u32 v5, v5, v6
    buffer_load_dwordx4 v[8:11], v5, s[12:15], 0 offen
    buffer_load_dwordx4 v[12:15], v5, s[12:15], 0 offen offset:32
    v_lshlrev_b32 v6, 4, v0
    s_lshl_b32 s24, s20, 17
    s_add_u32 s24, s24, 0x400000
    v_add_u32 v16, s24, v6
    v_lshrrev_b32 v7, 2, v0
    v_and_b32 v17, 3, v0
    v_lshrrev_b32 v18, 2, v7
    v_and_b32 v18, 3, v18
    v_xor_b32 v17, v17, v18
    v_lshlrev_b32 v17, 4, v17
    v_lshlrev_b32 v18, 6, v7
    v_add_u32 v17, v17, v18
    v_lshrrev_b32 v7, 5, v0
    v_and_b32 v19, 31, v0
    s_lshl_b32 s25, s20, 17
    s_add_u32 s25, s25, 0x800000
    v_lshlrev_b32 v18, 12, v7
    v_lshlrev_b32 v20, 4, v19
    v_add_u32 v18, v18, v20
    v_add_u32 v18, s25, v18
    v_mul_u32_u24 v19, 528, v7
    v_add_u32 v19, v19, v20
    v_add_u32 v19, 16384, v19
    v_lshrrev_b32 v6, 2, v3
    v_and_b32 v6, 3, v6
    v_xor_b32 v6, v6, v4
    v_lshlrev_b32 v21, 6, v3
    v_lshlrev_b32 v7, 4, v6
    v_add_u32 v22, v21, v7
    v_xor_b32 v6, 2, v6
    v_lshlrev_b32 v7, 4, v6
    v_add_u32 v23, v21, v7
    v_mul_u32_u24 v24, 528, v3
    v_lshlrev_b32 v7, 4, v4
    v_add_u32 v24, v24, v7
    v_add_u32 v24, 16384, v24
    s_mov_b32 s30, 0x3eae1a93
    v_mov_b32 v80, 0
    v_mov_b32 v81, 0
    v_mov_b32 v82, 0
    v_mov_b32 v83, 0
    v_mov_b32 v84, 0
    v_mov_b32 v85, 0
    v_mov_b32 v86, 0
    v_mov_b32 v87, 0
    v_mov_b32 v88, 0
    v_mov_b32 v89, 0
    v_mov_b32 v90, 0
    v_mov_b32 v91, 0
    v_mov_b32 v92, 0
    v_mov_b32 v93, 0
    v_mov_b32 v94, 0
    v_mov_b32 v95, 0
    v_mov_b32 v61, 0xff800000
    s_mov_b32 s36, 0
    s_mov_b32 s35, 0
    s_min_u32 s37, s36, 7
    s_mul_i32 s26, s37, 16384
    s_add_u32 s27, s26, 8192
    s_mul_i32 s28, s37, 512
    s_add_u32 s29, s28, 65536
    buffer_load_dwordx4 v[64:67], v16, s[12:15], s26 offen
    buffer_load_dwordx4 v[68:71], v16, s[12:15], s27 offen
    buffer_load_dwordx4 v[72:75], v18, s[12:15], s28 offen
    buffer_load_dwordx4 v[76:79], v18, s[12:15], s29 offen
    s_waitcnt vmcnt(0)
    v_add_u32 v29, s35, v17
    v_add_u32 v30, s35, v19
    ds_write_b128 v29, v[64:67]
    ds_write_b128 v29, v[68:71] offset:8192
    ds_write_b128 v30, v[72:75]
    ds_write_b128 v30, v[76:79] offset:8448
    s_waitcnt lgkmcnt(0)
    s_barrier
    s_mov_b32 s34, 0
k2_ch:
    s_add_u32 s36, s36, 1
    s_sub_u32 s35, 33280, s34
    s_min_u32 s37, s36, 7
    s_mul_i32 s26, s37, 16384
    s_add_u32 s27, s26, 8192
    s_mul_i32 s28, s37, 512
    s_add_u32 s29, s28, 65536
    buffer_load_dwordx4 v[64:67], v16, s[12:15], s26 offen
    buffer_load_dwordx4 v[68:71], v16, s[12:15], s27 offen
    buffer_load_dwordx4 v[72:75], v18, s[12:15], s28 offen
    buffer_load_dwordx4 v[76:79], v18, s[12:15], s29 offen
    s_mov_b32 s31, 0
kt_400001:
    s_lshl_b32 s32, s31, 12
    s_lshl_b32 s33, s31, 7
    s_add_u32 s32, s32, s34
    s_add_u32 s33, s33, s34
    v_add_u32 v26, s32, v22
    v_add_u32 v27, s32, v23
    v_add_u32 v28, s33, v24
    ds_read_b128 v[32:35], v26 offset:0
    ds_read_b128 v[36:39], v27 offset:0
    ds_read_b128 v[120:123], v26 offset:2048
    ds_read_b128 v[124:127], v27 offset:2048
    s_waitcnt lgkmcnt(2)
    v_mfma_f32_32x32x16_bf16 v[96:111], v[32:35], v[8:11], 0
    v_mfma_f32_32x32x16_bf16 v[96:111], v[36:39], v[12:15], v[96:111]
    s_waitcnt lgkmcnt(0)
    v_mfma_f32_32x32x16_bf16 v[128:143], v[120:123], v[8:11], 0
    v_mfma_f32_32x32x16_bf16 v[128:143], v[124:127], v[12:15], v[128:143]
    ds_read_b128 v[40:43], v28 offset:0
    ds_read_b128 v[44:47], v28 offset:32
    ds_read_b128 v[32:35], v28 offset:64
    ds_read_b128 v[36:39], v28 offset:96
    s_nop 7
    v_max3_f32 v48, v96, v97, v98
    v_max3_f32 v48, v48, v99, v100
    v_max3_f32 v48, v48, v101, v102
    v_max3_f32 v48, v48, v103, v104
    v_max3_f32 v48, v48, v105, v106
    v_max3_f32 v48, v48, v107, v108
    v_max3_f32 v48, v48, v109, v110
    v_max_f32 v48, v48, v111
    s_nop 3
    v_max3_f32 v48, v48, v128, v129
    v_max3_f32 v48, v48, v130, v131
    v_max3_f32 v48, v48, v132, v133
    v_max3_f32 v48, v48, v134, v135
    v_max3_f32 v48, v48, v136, v137
    v_max3_f32 v48, v48, v138, v139
    v_max3_f32 v48, v48, v140, v141
    v_max3_f32 v48, v48, v142, v143
    v_mov_b32 v49, v48
    s_nop 1
    v_permlane32_swap_b32 v48, v49
    v_max_f32 v48, v48, v49
    v_mul_f32 v48, s30, v48
    v_max_f32 v48, v48, v61
    v_sub_f32 v49, v61, v48
    v_exp_f32 v49, v49
    v_mov_b32 v61, v48
    v_fma_f32 v96, v96, s30, -v48
    v_exp_f32 v96, v96
    v_fma_f32 v97, v97, s30, -v48
    v_exp_f32 v97, v97
    v_fma_f32 v98, v98, s30, -v48
    v_exp_f32 v98, v98
    v_fma_f32 v99, v99, s30, -v48
    v_exp_f32 v99, v99
    v_fma_f32 v100, v100, s30, -v48
    v_exp_f32 v100, v100
    v_fma_f32 v101, v101, s30, -v48
    v_exp_f32 v101, v101
    v_fma_f32 v102, v102, s30, -v48
    v_exp_f32 v102, v102
    v_fma_f32 v103, v103, s30, -v48
    v_exp_f32 v103, v103
    v_fma_f32 v104, v104, s30, -v48
    v_exp_f32 v104, v104
    v_fma_f32 v105, v105, s30, -v48
    v_exp_f32 v105, v105
    v_fma_f32 v106, v106, s30, -v48
    v_exp_f32 v106, v106
    v_fma_f32 v107, v107, s30, -v48
    v_exp_f32 v107, v107
    v_fma_f32 v108, v108, s30, -v48
    v_exp_f32 v108, v108
    v_fma_f32 v109, v109, s30, -v48
    v_exp_f32 v109, v109
    v_fma_f32 v110, v110, s30, -v48
    v_exp_f32 v110, v110
    v_fma_f32 v111, v111, s30, -v48
    v_exp_f32 v111, v111
    v_mul_f32 v80, v49, v80
    v_mul_f32 v81, v49, v81
    v_mul_f32 v82, v49, v82
    v_mul_f32 v83, v49, v83
    v_mul_f32 v84, v49, v84
    v_mul_f32 v85, v49, v85
    v_mul_f32 v86, v49, v86
    v_mul_f32 v87, v49, v87
    v_mul_f32 v88, v49, v88
    v_mul_f32 v89, v49, v89
    v_mul_f32 v90, v49, v90
    v_mul_f32 v91, v49, v91
    v_cvt_pk_bf16_f32 v112, v96, v97
    v_cvt_pk_bf16_f32 v113, v98, v99
    v_cvt_pk_bf16_f32 v114, v100, v101
    v_cvt_pk_bf16_f32 v115, v102, v103
    v_cvt_pk_bf16_f32 v116, v104, v105
    v_cvt_pk_bf16_f32 v117, v106, v107
    v_cvt_pk_bf16_f32 v118, v108, v109
    v_cvt_pk_bf16_f32 v119, v110, v111
    s_waitcnt lgkmcnt(2)
    s_nop 1
    v_mfma_f32_32x32x16_bf16 v[80:95], v[40:43], v[112:115], v[80:95]
    v_mfma_f32_32x32x16_bf16 v[80:95], v[44:47], v[116:119], v[80:95]
    v_fma_f32 v128, v128, s30, -v48
    v_exp_f32 v128, v128
    v_fma_f32 v129, v129, s30, -v48
    v_exp_f32 v129, v129
    v_fma_f32 v130, v130, s30, -v48
    v_exp_f32 v130, v130
    v_fma_f32 v131, v131, s30, -v48
    v_exp_f32 v131, v131
    v_fma_f32 v132, v132, s30, -v48
    v_exp_f32 v132, v132
    v_fma_f32 v133, v133, s30, -v48
    v_exp_f32 v133, v133
    v_fma_f32 v134, v134, s30, -v48
    v_exp_f32 v134, v134
    v_fma_f32 v135, v135, s30, -v48
    v_exp_f32 v135, v135
    v_fma_f32 v136, v136, s30, -v48
    v_exp_f32 v136, v136
    v_fma_f32 v137, v137, s30, -v48
    v_exp_f32 v137, v137
    v_fma_f32 v138, v138, s30, -v48
    v_exp_f32 v138, v138
    v_fma_f32 v139, v139, s30, -v48
    v_exp_f32 v139, v139
    v_fma_f32 v140, v140, s30, -v48
    v_exp_f32 v140, v140
    v_fma_f32 v141, v141, s30, -v48
    v_exp_f32 v141, v141
    v_fma_f32 v142, v142, s30, -v48
    v_exp_f32 v142, v142
    v_fma_f32 v143, v143, s30, -v48
    v_exp_f32 v143, v143
    v_cvt_pk_bf16_f32 v96, v128, v129
    v_cvt_pk_bf16_f32 v97, v130, v131
    v_cvt_pk_bf16_f32 v98, v132, v133
    v_cvt_pk_bf16_f32 v99, v134, v135
    v_cvt_pk_bf16_f32 v100, v136, v137
    v_cvt_pk_bf16_f32 v101, v138, v139
    v_cvt_pk_bf16_f32 v102, v140, v141
    v_cvt_pk_bf16_f32 v103, v142, v143
    s_waitcnt lgkmcnt(0)
    s_nop 1
    v_mfma_f32_32x32x16_bf16 v[80:95], v[32:35], v[96:99], v[80:95]
    v_mfma_f32_32x32x16_bf16 v[80:95], v[36:39], v[100:103], v[80:95]
    s_add_u32 s31, s31, 1
    s_cmp_lt_u32 s31, 4
    s_cbranch_scc1 kt_400001
    s_waitcnt vmcnt(0)
    v_add_u32 v29, s35, v17
    v_add_u32 v30, s35, v19
    ds_write_b128 v29, v[64:67]
    ds_write_b128 v29, v[68:71] offset:8192
    ds_write_b128 v30, v[72:75]
    ds_write_b128 v30, v[76:79] offset:8448
    s_waitcnt lgkmcnt(0)
    s_barrier
    s_mov_b32 s34, s35
    s_cmp_lt_u32 s36, 8
    s_cbranch_scc1 k2_ch
    s_nop 15
    s_nop 3
    v_mov_b32 v48, v90
    v_mov_b32 v49, v90
    s_nop 1
    v_permlane32_swap_b32 v49, v48
    v_rcp_f32 v49, v49
    s_nop 0
    v_mul_f32 v80, v49, v80
    v_mul_f32 v81, v49, v81
    v_mul_f32 v82, v49, v82
    v_mul_f32 v83, v49, v83
    v_mul_f32 v84, v49, v84
    v_mul_f32 v85, v49, v85
    v_mul_f32 v86, v49, v86
    v_mul_f32 v87, v49, v87
    v_mul_f32 v88, v49, v88
    v_mul_f32 v89, v49, v89
    v_mul_f32 v90, v49, v90
    v_mul_f32 v91, v49, v91
    v_cvt_pk_bf16_f32 v112, v80, v81
    v_cvt_pk_bf16_f32 v113, v82, v83
    v_cvt_pk_bf16_f32 v114, v84, v85
    v_cvt_pk_bf16_f32 v115, v86, v87
    v_cvt_pk_bf16_f32 v116, v88, v89
    v_cvt_pk_bf16_f32 v117, v90, v91
    s_mov_b32 s26, 1152
    v_mul_lo_u32 v5, v60, s26
    s_mul_i32 s27, s20, 36
    v_add_u32 v5, s27, v5
    v_lshlrev_b32 v6, 3, v4
    v_add_u32 v5, v5, v6
    buffer_store_dword v112, v5, s[16:19], 0 offen
    buffer_store_dword v113, v5, s[16:19], 0 offen offset:4
    buffer_store_dword v114, v5, s[16:19], 0 offen offset:16
    buffer_store_dword v115, v5, s[16:19], 0 offen offset:20
    v_cmp_eq_u32 vcc, 0, v4
    s_and_saveexec_b64 s[26:27], vcc
    buffer_store_dword v116, v5, s[16:19], 0 offen offset:32
k2_end:
    s_endpgm

.globl k3_kernel
.p2align 8
.type k3_kernel,@function
k3_kernel:
    s_cmp_ge_u32 s2, 64
    s_cbranch_scc1 k3_end
    s_load_dwordx2 s[4:5], s[0:1], 0
    s_load_dwordx2 s[6:7], s[0:1], 16
    s_load_dwordx2 s[8:9], s[0:1], 88
    s_waitcnt lgkmcnt(0)
    s_add_u32 s40, s8, 0xd00000
    s_addc_u32 s41, s9, 0
    s_and_b32 s41, s41, 0xffff
    s_mov_b32 s42, 0x240000
    s_mov_b32 s43, 0x00020000
    s_mov_b32 s44, s6
    s_mov_b32 s45, s7
    s_and_b32 s45, s45, 0xffff
    s_mov_b32 s46, 0xa2000
    s_mov_b32 s47, 0x00020000
    s_mov_b32 s52, s8
    s_mov_b32 s53, s9
    s_and_b32 s53, s53, 0xffff
    s_mov_b32 s54, 0x20000
    s_mov_b32 s55, 0x00020000
    s_add_u32 s56, s8, 0x1000000
    s_addc_u32 s57, s9, 0
    s_and_b32 s57, s57, 0xffff
    s_mov_b32 s58, 0x240000
    s_mov_b32 s59, 0x00020000
    s_mov_b32 s60, s4
    s_mov_b32 s61, s5
    s_and_b32 s61, s61, 0xffff
    s_mov_b32 s62, 0x240000
    s_mov_b32 s63, 0x00020000
    s_lshr_b32 s10, s2, 2
    s_and_b32 s11, s2, 3
    s_lshl_b32 s20, s10, 7
    s_mul_i32 s21, s11, 144
    s_mov_b32 s22, 0
    v_and_b32 v1, 63, v0
    v_lshrrev_b32 v2, 6, v0
    s_nop 0
    v_readfirstlane_b32 s23, v2
    s_mov_b32 s24, 0
    s_mov_b32 s25, s23
    s_mov_b32 s26, 1152
    s_mul_i32 s27, s23, 32
    v_lshrrev_b32 v3, 3, v1
    v_add_u32 v3, 0, v3
    v_add_u32 v3, s27, v3
    v_lshrrev_b32 v4, 1, v3
    v_and_b32 v4, 7, v4
    v_and_b32 v5, 7, v1
    v_xor_b32 v4, v4, v5
    v_add_u32 v3, s20, v3
    v_mul_lo_u32 v8, v3, s26
    v_lshlrev_b32 v4, 4, v4
    v_add_u32 v8, v8, v4
    v_lshrrev_b32 v3, 3, v1
    v_add_u32 v3, 8, v3
    v_add_u32 v3, s27, v3
    v_lshrrev_b32 v4, 1, v3
    v_and_b32 v4, 7, v4
    v_and_b32 v5, 7, v1
    v_xor_b32 v4, v4, v5
    v_add_u32 v3, s20, v3
    v_mul_lo_u32 v9, v3, s26
    v_lshlrev_b32 v4, 4, v4
    v_add_u32 v9, v9, v4
    v_lshrrev_b32 v3, 3, v1
    v_add_u32 v3, 16, v3
    v_add_u32 v3, s27, v3
    v_lshrrev_b32 v4, 1, v3
    v_and_b32 v4, 7, v4
    v_and_b32 v5, 7, v1
    v_xor_b32 v4, v4, v5
    v_add_u32 v3, s20, v3
    v_mul_lo_u32 v10, v3, s26
    v_lshlrev_b32 v4, 4, v4
    v_add_u32 v10, v10, v4
    v_lshrrev_b32 v3, 3, v1
    v_add_u32 v3, 24, v3
    v_add_u32 v3, s27, v3
    v_lshrrev_b32 v4, 1, v3
    v_and_b32 v4, 7, v4
    v_and_b32 v5, 7, v1
    v_xor_b32 v4, v4, v5
    v_add_u32 v3, s20, v3
    v_mul_lo_u32 v11, v3, s26
    v_lshlrev_b32 v4, 4, v4
    v_add_u32 v11, v11, v4
    s_mov_b32 s27, 1152
    s_lshl_b32 s28, s21, 1
    s_add_u32 s29, s23, 0
    s_min_u32 s29, s29, 17
    s_lshl_b32 s29, s29, 6
    v_add_u32 v5, s29, v1
    s_mov_b32 s29, 3641
    v_mul_lo_u32 v6, v5, s29
    v_lshrrev_b32 v6, 16, v6
    v_mul_u32_u24 v7, 18, v6
    v_sub_u32 v7, v5, v7
    v_and_b32 v3, 32, v6
    v_bfe_u32 v4, v6, 4, 1
    v_lshlrev_b32 v4, 2, v4
    v_add_u32 v3, v3, v4
    v_bfe_u32 v4, v6, 2, 2
    v_lshlrev_b32 v4, 3, v4
    v_add_u32 v3, v3, v4
    v_and_b32 v4, 3, v6
    v_add_u32 v3, v3, v4
    v_mul_lo_u32 v17, v3, s27
    v_lshlrev_b32 v7, 4, v7
    v_add_u32 v17, v17, v7
    v_add_u32 v17, s28, v17
    s_add_u32 s29, s23, 4
    s_min_u32 s29, s29, 17
    s_lshl_b32 s29, s29, 6
    v_add_u32 v5, s29, v1
    s_mov_b32 s29, 3641
    v_mul_lo_u32 v6, v5, s29
    v_lshrrev_b32 v6, 16, v6
    v_mul_u32_u24 v7, 18, v6
    v_sub_u32 v7, v5, v7
    v_and_b32 v3, 32, v6
    v_bfe_u32 v4, v6, 4, 1
    v_lshlrev_b32 v4, 2, v4
    v_add_u32 v3, v3, v4
    v_bfe_u32 v4, v6, 2, 2
    v_lshlrev_b32 v4, 3, v4
    v_add_u32 v3, v3, v4
    v_and_b32 v4, 3, v6
    v_add_u32 v3, v3, v4
    v_mul_lo_u32 v18, v3, s27
    v_lshlrev_b32 v7, 4, v7
    v_add_u32 v18, v18, v7
    v_add_u32 v18, s28, v18
    s_add_u32 s29, s23, 8
    s_min_u32 s29, s29, 17
    s_lshl_b32 s29, s29, 6
    v_add_u32 v5, s29, v1
    s_mov_b32 s29, 3641
    v_mul_lo_u32 v6, v5, s29
    v_lshrrev_b32 v6, 16, v6
    v_mul_u32_u24 v7, 18, v6
    v_sub_u32 v7, v5, v7
    v_and_b32 v3, 32, v6
    v_bfe_u32 v4, v6, 4, 1
    v_lshlrev_b32 v4, 2, v4
    v_add_u32 v3, v3, v4
    v_bfe_u32 v4, v6, 2, 2
    v_lshlrev_b32 v4, 3, v4
    v_add_u32 v3, v3, v4
    v_and_b32 v4, 3, v6
    v_add_u32 v3, v3, v4
    v_mul_lo_u32 v19, v3, s27
    v_lshlrev_b32 v7, 4, v7
    v_add_u32 v19, v19, v7
    v_add_u32 v19, s28, v19
    s_add_u32 s29, s23, 12
    s_min_u32 s29, s29, 17
    s_lshl_b32 s29, s29, 6
    v_add_u32 v5, s29, v1
    s_mov_b32 s29, 3641
    v_mul_lo_u32 v6, v5, s29
    v_lshrrev_b32 v6, 16, v6
    v_mul_u32_u24 v7, 18, v6
    v_sub_u32 v7, v5, v7
    v_and_b32 v3, 32, v6
    v_bfe_u32 v4, v6, 4, 1
    v_lshlrev_b32 v4, 2, v4
    v_add_u32 v3, v3, v4
    v_bfe_u32 v4, v6, 2, 2
    v_lshlrev_b32 v4, 3, v4
    v_add_u32 v3, v3, v4
    v_and_b32 v4, 3, v6
    v_add_u32 v3, v3, v4
    v_mul_lo_u32 v20, v3, s27
    v_lshlrev_b32 v7, 4, v7
    v_add_u32 v20, v20, v7
    v_add_u32 v20, s28, v20
    s_add_u32 s29, s23, 16
    s_min_u32 s29, s29, 17
    s_lshl_b32 s29, s29, 6
    v_add_u32 v5, s29, v1
    s_mov_b32 s29, 3641
    v_mul_lo_u32 v6, v5, s29
    v_lshrrev_b32 v6, 16, v6
    v_mul_u32_u24 v7, 18, v6
    v_sub_u32 v7, v5, v7
    v_and_b32 v3, 32, v6
    v_bfe_u32 v4, v6, 4, 1
    v_lshlrev_b32 v4, 2, v4
    v_add_u32 v3, v3, v4
    v_bfe_u32 v4, v6, 2, 2
    v_lshlrev_b32 v4, 3, v4
    v_add_u32 v3, v3, v4
    v_and_b32 v4, 3, v6
    v_add_u32 v3, v3, v4
    v_mul_lo_u32 v21, v3, s27
    v_lshlrev_b32 v7, 4, v7
    v_add_u32 v21, v21, v7
    v_add_u32 v21, s28, v21
    v_and_b32 v5, 15, v1
    v_lshrrev_b32 v6, 4, v1
    v_lshrrev_b32 v7, 1, v5
    v_xor_b32 v7, v7, v6
    s_lshl_b32 s26, s25, 12
    v_lshlrev_b32 v27, 7, v5
    v_add_u32 v27, s26, v27
    v_xor_b32 v28, 4, v7
    v_lshlrev_b32 v28, 4, v28
    v_add_u32 v28, v27, v28
    v_lshlrev_b32 v7, 4, v7
    v_add_u32 v27, v27, v7
    v_and_b32 v5, 15, v1
    v_lshrrev_b32 v6, 4, v1
    v_lshrrev_b32 v7, 2, v5
    v_lshlrev_b32 v31, 2, v6
    v_add_u32 v31, v31, v7
    v_mul_u32_u24 v31, 288, v31
    v_and_b32 v5, 3, v5
    v_lshlrev_b32 v5, 3, v5
    v_add_u32 v31, v31, v5
    v_add_u32 v31, 16384, v31
    s_mov_b32 s70, 0
    s_mov_b32 s71, 0
    s_mov_b32 s73, 0
    s_min_u32 s72, s70, 8
    s_lshl_b32 s30, s72, 6
    s_add_u32 s30, s30, s22
    s_mul_i32 s31, s30, 1152
    s_lshl_b32 s30, s30, 1
    s_mul_i32 s32, s23, 4096
    s_add_u32 s32, s32, s71
    s_add_u32 m0, s32, 0
    s_nop 0
    buffer_load_dwordx4 v8, s[40:43], s30 offen lds
    s_add_u32 m0, s32, 1024
    s_nop 0
    buffer_load_dwordx4 v9, s[40:43], s30 offen lds
    s_add_u32 m0, s32, 2048
    s_nop 0
    buffer_load_dwordx4 v10, s[40:43], s30 offen lds
    s_add_u32 m0, s32, 3072
    s_nop 0
    buffer_load_dwordx4 v11, s[40:43], s30 offen lds
    s_add_u32 s33, s23, 0
    s_min_u32 s33, s33, 17
    s_lshl_b32 s33, s33, 10
    s_add_u32 s33, s33, s71
    s_add_u32 m0, s33, 16384
    s_nop 0
    buffer_load_dwordx4 v17, s[44:47], s31 offen lds
    s_add_u32 s33, s23, 4
    s_min_u32 s33, s33, 17
    s_lshl_b32 s33, s33, 10
    s_add_u32 s33, s33, s71
    s_add_u32 m0, s33, 16384
    s_nop 0
    buffer_load_dwordx4 v18, s[44:47], s31 offen lds
    s_add_u32 s33, s23, 8
    s_min_u32 s33, s33, 17
    s_lshl_b32 s33, s33, 10
    s_add_u32 s33, s33, s71
    s_add_u32 m0, s33, 16384
    s_nop 0
    buffer_load_dwordx4 v19, s[44:47], s31 offen lds
    s_add_u32 s33, s23, 12
    s_min_u32 s33, s33, 17
    s_lshl_b32 s33, s33, 10
    s_add_u32 s33, s33, s71
    s_add_u32 m0, s33, 16384
    s_nop 0
    buffer_load_dwordx4 v20, s[44:47], s31 offen lds
    s_add_u32 s33, s23, 16
    s_min_u32 s33, s33, 17
    s_lshl_b32 s33, s33, 10
    s_add_u32 s33, s33, s71
    s_add_u32 m0, s33, 16384
    s_nop 0
    buffer_load_dwordx4 v21, s[44:47], s31 offen lds
    s_add_u32 s70, s70, 1
    s_add_u32 s71, s71, 34816
    s_cmp_ge_u32 s71, 139264
    s_cselect_b32 s71, 0, s71
    s_min_u32 s72, s70, 8
    s_lshl_b32 s30, s72, 6
    s_add_u32 s30, s30, s22
    s_mul_i32 s31, s30, 1152
    s_lshl_b32 s30, s30, 1
    s_mul_i32 s32, s23, 4096
    s_add_u32 s32, s32, s71
    s_add_u32 m0, s32, 0
    s_nop 0
    buffer_load_dwordx4 v8, s[40:43], s30 offen lds
    s_add_u32 m0, s32, 1024
    s_nop 0
    buffer_load_dwordx4 v9, s[40:43], s30 offen lds
    s_add_u32 m0, s32, 2048
    s_nop 0
    buffer_load_dwordx4 v10, s[40:43], s30 offen lds
    s_add_u32 m0, s32, 3072
    s_nop 0
    buffer_load_dwordx4 v11, s[40:43], s30 offen lds
    s_add_u32 s33, s23, 0
    s_min_u32 s33, s33, 17
    s_lshl_b32 s33, s33, 10
    s_add_u32 s33, s33, s71
    s_add_u32 m0, s33, 16384
    s_nop 0
    buffer_load_dwordx4 v17, s[44:47], s31 offen lds
    s_add_u32 s33, s23, 4
    s_min_u32 s33, s33, 17
    s_lshl_b32 s33, s33, 10
    s_add_u32 s33, s33, s71
    s_add_u32 m0, s33, 16384
    s_nop 0
    buffer_load_dwordx4 v18, s[44:47], s31 offen lds
    s_add_u32 s33, s23, 8
    s_min_u32 s33, s33, 17
    s_lshl_b32 s33, s33, 10
    s_add_u32 s33, s33, s71
    s_add_u32 m0, s33, 16384
    s_nop 0
    buffer_load_dwordx4 v19, s[44:47], s31 offen lds
    s_add_u32 s33, s23, 12
    s_min_u32 s33, s33, 17
    s_lshl_b32 s33, s33, 10
    s_add_u32 s33, s33, s71
    s_add_u32 m0, s33, 16384
    s_nop 0
    buffer_load_dwordx4 v20, s[44:47], s31 offen lds
    s_add_u32 s33, s23, 16
    s_min_u32 s33, s33, 17
    s_lshl_b32 s33, s33, 10
    s_add_u32 s33, s33, s71
    s_add_u32 m0, s33, 16384
    s_nop 0
    buffer_load_dwordx4 v21, s[44:47], s31 offen lds
    s_add_u32 s70, s70, 1
    s_add_u32 s71, s71, 34816
    s_cmp_ge_u32 s71, 139264
    s_cselect_b32 s71, 0, s71
    s_min_u32 s72, s70, 8
    s_lshl_b32 s30, s72, 6
    s_add_u32 s30, s30, s22
    s_mul_i32 s31, s30, 1152
    s_lshl_b32 s30, s30, 1
    s_mul_i32 s32, s23, 4096
    s_add_u32 s32, s32, s71
    s_add_u32 m0, s32, 0
    s_nop 0
    buffer_load_dwordx4 v8, s[40:43], s30 offen lds
    s_add_u32 m0, s32, 1024
    s_nop 0
    buffer_load_dwordx4 v9, s[40:43], s30 offen lds
    s_add_u32 m0, s32, 2048
    s_nop 0
    buffer_load_dwordx4 v10, s[40:43], s30 offen lds
    s_add_u32 m0, s32, 3072
    s_nop 0
    buffer_load_dwordx4 v11, s[40:43], s30 offen lds
    s_add_u32 s33, s23, 0
    s_min_u32 s33, s33, 17
    s_lshl_b32 s33, s33, 10
    s_add_u32 s33, s33, s71
    s_add_u32 m0, s33, 16384
    s_nop 0
    buffer_load_dwordx4 v17, s[44:47], s31 offen lds
    s_add_u32 s33, s23, 4
    s_min_u32 s33, s33, 17
    s_lshl_b32 s33, s33, 10
    s_add_u32 s33, s33, s71
    s_add_u32 m0, s33, 16384
    s_nop 0
    buffer_load_dwordx4 v18, s[44:47], s31 offen lds
    s_add_u32 s33, s23, 8
    s_min_u32 s33, s33, 17
    s_lshl_b32 s33, s33, 10
    s_add_u32 s33, s33, s71
    s_add_u32 m0, s33, 16384
    s_nop 0
    buffer_load_dwordx4 v19, s[44:47], s31 offen lds
    s_add_u32 s33, s23, 12
    s_min_u32 s33, s33, 17
    s_lshl_b32 s33, s33, 10
    s_add_u32 s33, s33, s71
    s_add_u32 m0, s33, 16384
    s_nop 0
    buffer_load_dwordx4 v20, s[44:47], s31 offen lds
    s_add_u32 s33, s23, 16
    s_min_u32 s33, s33, 17
    s_lshl_b32 s33, s33, 10
    s_add_u32 s33, s33, s71
    s_add_u32 m0, s33, 16384
    s_nop 0
    buffer_load_dwordx4 v21, s[44:47], s31 offen lds
    s_add_u32 s70, s70, 1
    s_add_u32 s71, s71, 34816
    s_cmp_ge_u32 s71, 139264
    s_cselect_b32 s71, 0, s71
    v_mov_b32 v96, 0
    v_mov_b32 v97, 0
    v_mov_b32 v98, 0
    v_mov_b32 v99, 0
    v_mov_b32 v100, 0
    v_mov_b32 v101, 0
    v_mov_b32 v102, 0
    v_mov_b32 v103, 0
    v_mov_b32 v104, 0
    v_mov_b32 v105, 0
    v_mov_b32 v106, 0
    v_mov_b32 v107, 0
    v_mov_b32 v108, 0
    v_mov_b32 v109, 0
    v_mov_b32 v110, 0
    v_mov_b32 v111, 0
    v_mov_b32 v112, 0
    v_mov_b32 v113, 0
    v_mov_b32 v114, 0
    v_mov_b32 v115, 0
    v_mov_b32 v116, 0
    v_mov_b32 v117, 0
    v_mov_b32 v118, 0
    v_mov_b32 v119, 0
    v_mov_b32 v120, 0
    v_mov_b32 v121, 0
    v_mov_b32 v122, 0
    v_mov_b32 v123, 0
    v_mov_b32 v124, 0
    v_mov_b32 v125, 0
    v_mov_b32 v126, 0
    v_mov_b32 v127, 0
    v_mov_b32 v128, 0
    v_mov_b32 v129, 0
    v_mov_b32 v130, 0
    v_mov_b32 v131, 0
    v_mov_b32 v132, 0
    v_mov_b32 v133, 0
    v_mov_b32 v134, 0
    v_mov_b32 v135, 0
    v_mov_b32 v136, 0
    v_mov_b32 v137, 0
    v_mov_b32 v138, 0
    v_mov_b32 v139, 0
    v_mov_b32 v140, 0
    v_mov_b32 v141, 0
    v_mov_b32 v142, 0
    v_mov_b32 v143, 0
    v_mov_b32 v144, 0
    v_mov_b32 v145, 0
    v_mov_b32 v146, 0
    v_mov_b32 v147, 0
    v_mov_b32 v148, 0
    v_mov_b32 v149, 0
    v_mov_b32 v150, 0
    v_mov_b32 v151, 0
    v_mov_b32 v152, 0
    v_mov_b32 v153, 0
    v_mov_b32 v154, 0
    v_mov_b32 v155, 0
    v_mov_b32 v156, 0
    v_mov_b32 v157, 0
    v_mov_b32 v158, 0
    v_mov_b32 v159, 0
    v_mov_b32 v160, 0
    v_mov_b32 v161, 0
    v_mov_b32 v162, 0
    v_mov_b32 v163, 0
    v_mov_b32 v164, 0
    v_mov_b32 v165, 0
    v_mov_b32 v166, 0
    v_mov_b32 v167, 0
    s_mov_b32 s74, 0
kloop_500001:
    s_waitcnt vmcnt(18) lgkmcnt(0)
    s_barrier
    v_add_u32 v33, s73, v27
    v_add_u32 v34, s73, v28
    v_add_u32 v35, s73, v31
    ds_read_b128 v[40:43], v33 offset:0
    ds_read_b128 v[44:47], v33 offset:2048
    ds_read_b64_tr_b16 v[56:57], v35 offset:0
    ds_read_b64_tr_b16 v[58:59], v35 offset:4608
    ds_read_b64_tr_b16 v[60:61], v35 offset:32
    ds_read_b64_tr_b16 v[62:63], v35 offset:4640
    ds_read_b64_tr_b16 v[64:65], v35 offset:64
    ds_read_b64_tr_b16 v[66:67], v35 offset:4672
    s_waitcnt lgkmcnt(4)
    v_mfma_f32_16x16x32_bf16 v[96:99], v[56:59], v[40:43], v[96:99]
    v_mfma_f32_16x16x32_bf16 v[100:103], v[56:59], v[44:47], v[100:103]
    ds_read_b64_tr_b16 v[68:69], v35 offset:96
    ds_read_b64_tr_b16 v[70:71], v35 offset:4704
    s_min_u32 s72, s70, 8
    s_lshl_b32 s30, s72, 6
    s_add_u32 s30, s30, s22
    s_mul_i32 s31, s30, 1152
    s_lshl_b32 s30, s30, 1
    s_mul_i32 s32, s23, 4096
    s_add_u32 s32, s32, s71
    s_add_u32 m0, s32, 0
    s_nop 0
    buffer_load_dwordx4 v8, s[40:43], s30 offen lds
    s_waitcnt lgkmcnt(4)
    v_mfma_f32_16x16x32_bf16 v[104:107], v[60:63], v[40:43], v[104:107]
    v_mfma_f32_16x16x32_bf16 v[108:111], v[60:63], v[44:47], v[108:111]
    ds_read_b64_tr_b16 v[56:57], v35 offset:128
    ds_read_b64_tr_b16 v[58:59], v35 offset:4736
    s_add_u32 m0, s32, 1024
    s_nop 0
    buffer_load_dwordx4 v9, s[40:43], s30 offen lds
    s_waitcnt lgkmcnt(4)
    v_mfma_f32_16x16x32_bf16 v[112:115], v[64:67], v[40:43], v[112:115]
    v_mfma_f32_16x16x32_bf16 v[116:119], v[64:67], v[44:47], v[116:119]
    ds_read_b64_tr_b16 v[60:61], v35 offset:160
    ds_read_b64_tr_b16 v[62:63], v35 offset:4768
    s_add_u32 m0, s32, 2048
    s_nop 0
    buffer_load_dwordx4 v10, s[40:43], s30 offen lds
    s_waitcnt lgkmcnt(4)
    v_mfma_f32_16x16x32_bf16 v[120:123], v[68:71], v[40:43], v[120:123]
    v_mfma_f32_16x16x32_bf16 v[124:127], v[68:71], v[44:47], v[124:127]
    ds_read_b64_tr_b16 v[64:65], v35 offset:192
    ds_read_b64_tr_b16 v[66:67], v35 offset:4800
    s_add_u32 m0, s32, 3072
    s_nop 0
    buffer_load_dwordx4 v11, s[40:43], s30 offen lds
    s_waitcnt lgkmcnt(4)
    v_mfma_f32_16x16x32_bf16 v[128:131], v[56:59], v[40:43], v[128:131]
    v_mfma_f32_16x16x32_bf16 v[132:135], v[56:59], v[44:47], v[132:135]
    ds_read_b64_tr_b16 v[68:69], v35 offset:224
    ds_read_b64_tr_b16 v[70:71], v35 offset:4832
    s_add_u32 s33, s23, 0
    s_min_u32 s33, s33, 17
    s_lshl_b32 s33, s33, 10
    s_add_u32 s33, s33, s71
    s_add_u32 m0, s33, 16384
    s_nop 0
    buffer_load_dwordx4 v17, s[44:47], s31 offen lds
    s_waitcnt lgkmcnt(4)
    v_mfma_f32_16x16x32_bf16 v[136:139], v[60:63], v[40:43], v[136:139]
    v_mfma_f32_16x16x32_bf16 v[140:143], v[60:63], v[44:47], v[140:143]
    ds_read_b64_tr_b16 v[56:57], v35 offset:256
    ds_read_b64_tr_b16 v[58:59], v35 offset:4864
    s_add_u32 s33, s23, 4
    s_min_u32 s33, s33, 17
    s_lshl_b32 s33, s33, 10
    s_add_u32 s33, s33, s71
    s_add_u32 m0, s33, 16384
    s_nop 0
    buffer_load_dwordx4 v18, s[44:47], s31 offen lds
    s_waitcnt lgkmcnt(4)
    v_mfma_f32_16x16x32_bf16 v[144:147], v[64:67], v[40:43], v[144:147]
    v_mfma_f32_16x16x32_bf16 v[148:151], v[64:67], v[44:47], v[148:151]
    s_add_u32 s33, s23, 8
    s_min_u32 s33, s33, 17
    s_lshl_b32 s33, s33, 10
    s_add_u32 s33, s33, s71
    s_add_u32 m0, s33, 16384
    s_nop 0
    buffer_load_dwordx4 v19, s[44:47], s31 offen lds
    s_waitcnt lgkmcnt(2)
    v_mfma_f32_16x16x32_bf16 v[152:155], v[68:71], v[40:43], v[152:155]
    v_mfma_f32_16x16x32_bf16 v[156:159], v[68:71], v[44:47], v[156:159]
    s_add_u32 s33, s23, 12
    s_min_u32 s33, s33, 17
    s_lshl_b32 s33, s33, 10
    s_add_u32 s33, s33, s71
    s_add_u32 m0, s33, 16384
    s_nop 0
    buffer_load_dwordx4 v20, s[44:47], s31 offen lds
    s_waitcnt lgkmcnt(0)
    v_mfma_f32_16x16x32_bf16 v[160:163], v[56:59], v[40:43], v[160:163]
    v_mfma_f32_16x16x32_bf16 v[164:167], v[56:59], v[44:47], v[164:167]
    s_add_u32 s33, s23, 16
    s_min_u32 s33, s33, 17
    s_lshl_b32 s33, s33, 10
    s_add_u32 s33, s33, s71
    s_add_u32 m0, s33, 16384
    s_nop 0
    buffer_load_dwordx4 v21, s[44:47], s31 offen lds
    ds_read_b128 v[40:43], v34 offset:0
    ds_read_b128 v[44:47], v34 offset:2048
    ds_read_b64_tr_b16 v[56:57], v35 offset:9216
    ds_read_b64_tr_b16 v[58:59], v35 offset:13824
    ds_read_b64_tr_b16 v[60:61], v35 offset:9248
    ds_read_b64_tr_b16 v[62:63], v35 offset:13856
    ds_read_b64_tr_b16 v[64:65], v35 offset:9280
    ds_read_b64_tr_b16 v[66:67], v35 offset:13888
    s_waitcnt lgkmcnt(4)
    v_mfma_f32_16x16x32_bf16 v[96:99], v[56:59], v[40:43], v[96:99]
    v_mfma_f32_16x16x32_bf16 v[100:103], v[56:59], v[44:47], v[100:103]
    ds_read_b64_tr_b16 v[68:69], v35 offset:9312
    ds_read_b64_tr_b16 v[70:71], v35 offset:13920
    s_waitcnt lgkmcnt(4)
    v_mfma_f32_16x16x32_bf16 v[104:107], v[60:63], v[40:43], v[104:107]
    v_mfma_f32_16x16x32_bf16 v[108:111], v[60:63], v[44:47], v[108:111]
    ds_read_b64_tr_b16 v[56:57], v35 offset:9344
    ds_read_b64_tr_b16 v[58:59], v35 offset:13952
    s_waitcnt lgkmcnt(4)
    v_mfma_f32_16x16x32_bf16 v[112:115], v[64:67], v[40:43], v[112:115]
    v_mfma_f32_16x16x32_bf16 v[116:119], v[64:67], v[44:47], v[116:119]
    ds_read_b64_tr_b16 v[60:61], v35 offset:9376
    ds_read_b64_tr_b16 v[62:63], v35 offset:13984
    s_waitcnt lgkmcnt(4)
    v_mfma_f32_16x16x32_bf16 v[120:123], v[68:71], v[40:43], v[120:123]
    v_mfma_f32_16x16x32_bf16 v[124:127], v[68:71], v[44:47], v[124:127]
    ds_read_b64_tr_b16 v[64:65], v35 offset:9408
    ds_read_b64_tr_b16 v[66:67], v35 offset:14016
    s_waitcnt lgkmcnt(4)
    v_mfma_f32_16x16x32_bf16 v[128:131], v[56:59], v[40:43], v[128:131]
    v_mfma_f32_16x16x32_bf16 v[132:135], v[56:59], v[44:47], v[132:135]
    ds_read_b64_tr_b16 v[68:69], v35 offset:9440
    ds_read_b64_tr_b16 v[70:71], v35 offset:14048
    s_waitcnt lgkmcnt(4)
    v_mfma_f32_16x16x32_bf16 v[136:139], v[60:63], v[40:43], v[136:139]
    v_mfma_f32_16x16x32_bf16 v[140:143], v[60:63], v[44:47], v[140:143]
    ds_read_b64_tr_b16 v[56:57], v35 offset:9472
    ds_read_b64_tr_b16 v[58:59], v35 offset:14080
    s_waitcnt lgkmcnt(4)
    v_mfma_f32_16x16x32_bf16 v[144:147], v[64:67], v[40:43], v[144:147]
    v_mfma_f32_16x16x32_bf16 v[148:151], v[64:67], v[44:47], v[148:151]
    s_waitcnt lgkmcnt(2)
    v_mfma_f32_16x16x32_bf16 v[152:155], v[68:71], v[40:43], v[152:155]
    v_mfma_f32_16x16x32_bf16 v[156:159], v[68:71], v[44:47], v[156:159]
    s_waitcnt lgkmcnt(0)
    v_mfma_f32_16x16x32_bf16 v[160:163], v[56:59], v[40:43], v[160:163]
    v_mfma_f32_16x16x32_bf16 v[164:167], v[56:59], v[44:47], v[164:167]
    s_add_u32 s70, s70, 1
    s_add_u32 s71, s71, 34816
    s_cmp_ge_u32 s71, 139264
    s_cselect_b32 s71, 0, s71
    s_add_u32 s73, s73, 34816
    s_cmp_ge_u32 s73, 139264
    s_cselect_b32 s73, 0, s73
    s_add_u32 s74, s74, 1
    s_cmp_lt_u32 s74, 9
    s_cbranch_scc1 kloop_500001
    s_waitcnt vmcnt(0)
    s_nop 7
    s_nop 7
    v_and_b32 v5, 15, v1
    s_lshl_b32 s26, s25, 5
    s_add_u32 s26, s26, s20
    v_add_u32 v5, s26, v5
    v_lshrrev_b32 v6, 4, v1
    v_lshlrev_b32 v6, 2, v6
    v_add_u32 v6, s21, v6
    s_mov_b32 s27, 1152
    v_mul_lo_u32 v7, v5, s27
    v_lshlrev_b32 v8, 1, v6
    v_add_u32 v7, v7, v8
    v_lshlrev_b32 v8, 2, v6
    v_add_u32 v8, 4608, v8
    buffer_load_dwordx4 v[168:171], v8, s[52:55], 0 offen offset:0
    buffer_load_dwordx4 v[172:175], v8, s[52:55], 0 offen offset:64
    buffer_load_dwordx4 v[176:179], v8, s[52:55], 0 offen offset:128
    buffer_load_dwordx4 v[180:183], v8, s[52:55], 0 offen offset:192
    buffer_load_dwordx4 v[184:187], v8, s[52:55], 0 offen offset:256
    buffer_load_dwordx4 v[188:191], v8, s[52:55], 0 offen offset:320
    buffer_load_dwordx4 v[192:195], v8, s[52:55], 0 offen offset:384
    buffer_load_dwordx4 v[196:199], v8, s[52:55], 0 offen offset:448
    buffer_load_dwordx4 v[200:203], v8, s[52:55], 0 offen offset:512
    buffer_load_dwordx2 v[204:205], v7, s[60:63], 0 offen offset:0
    buffer_load_dwordx2 v[206:207], v7, s[60:63], 0 offen offset:32
    buffer_load_dwordx2 v[208:209], v7, s[60:63], 0 offen offset:64
    buffer_load_dwordx2 v[210:211], v7, s[60:63], 0 offen offset:96
    buffer_load_dwordx2 v[212:213], v7, s[60:63], 0 offen offset:128
    buffer_load_dwordx2 v[214:215], v7, s[60:63], 0 offen offset:160
    buffer_load_dwordx2 v[216:217], v7, s[60:63], 0 offen offset:192
    buffer_load_dwordx2 v[218:219], v7, s[60:63], 0 offen offset:224
    buffer_load_dwordx2 v[220:221], v7, s[60:63], 0 offen offset:256
    s_waitcnt vmcnt(0)
    v_mov_b32 v60, 0
    v_mov_b32 v61, 0
    v_mov_b32 v40, v204
    v_mov_b32 v41, v205
    v_mov_b32 v44, v168
    v_mov_b32 v45, v169
    v_mov_b32 v46, v170
    v_mov_b32 v47, v171
    v_mov_b32 v48, v96
    v_mov_b32 v49, v97
    v_mov_b32 v50, v98
    v_mov_b32 v51, v99
    v_lshlrev_b32 v42, 16, v40
    v_and_b32 v43, 0xffff0000, v40
    v_and_b32 v52, 0xffff0000, v41
    v_lshlrev_b32 v41, 16, v41
    v_fma_f32 v48, v48, v44, v42
    v_fma_f32 v49, v49, v45, v43
    v_fma_f32 v50, v50, v46, v41
    v_fma_f32 v51, v51, v47, v52
    v_cvt_pk_bf16_f32 v40, v48, v49
    v_cvt_pk_bf16_f32 v41, v50, v51
    buffer_store_dwordx2 v[40:41], v7, s[56:59], 0 offen offset:0
    s_nop 1
    v_mov_b32 v40, v206
    v_mov_b32 v41, v207
    v_mov_b32 v44, v172
    v_mov_b32 v45, v173
    v_mov_b32 v46, v174
    v_mov_b32 v47, v175
    v_mov_b32 v48, v104
    v_mov_b32 v49, v105
    v_mov_b32 v50, v106
    v_mov_b32 v51, v107
    v_lshlrev_b32 v42, 16, v40
    v_and_b32 v43, 0xffff0000, v40
    v_and_b32 v52, 0xffff0000, v41
    v_lshlrev_b32 v41, 16, v41
    v_fma_f32 v48, v48, v44, v42
    v_fma_f32 v49, v49, v45, v43
    v_fma_f32 v50, v50, v46, v41
    v_fma_f32 v51, v51, v47, v52
    v_cvt_pk_bf16_f32 v40, v48, v49
    v_cvt_pk_bf16_f32 v41, v50, v51
    buffer_store_dwordx2 v[40:41], v7, s[56:59], 0 offen offset:32
    s_nop 1
    v_mov_b32 v40, v208
    v_mov_b32 v41, v209
    v_mov_b32 v44, v176
    v_mov_b32 v45, v177
    v_mov_b32 v46, v178
    v_mov_b32 v47, v179
    v_mov_b32 v48, v112
    v_mov_b32 v49, v113
    v_mov_b32 v50, v114
    v_mov_b32 v51, v115
    v_lshlrev_b32 v42, 16, v40
    v_and_b32 v43, 0xffff0000, v40
    v_and_b32 v52, 0xffff0000, v41
    v_lshlrev_b32 v41, 16, v41
    v_fma_f32 v48, v48, v44, v42
    v_fma_f32 v49, v49, v45, v43
    v_fma_f32 v50, v50, v46, v41
    v_fma_f32 v51, v51, v47, v52
    v_cvt_pk_bf16_f32 v40, v48, v49
    v_cvt_pk_bf16_f32 v41, v50, v51
    buffer_store_dwordx2 v[40:41], v7, s[56:59], 0 offen offset:64
    s_nop 1
    v_mov_b32 v40, v210
    v_mov_b32 v41, v211
    v_mov_b32 v44, v180
    v_mov_b32 v45, v181
    v_mov_b32 v46, v182
    v_mov_b32 v47, v183
    v_mov_b32 v48, v120
    v_mov_b32 v49, v121
    v_mov_b32 v50, v122
    v_mov_b32 v51, v123
    v_lshlrev_b32 v42, 16, v40
    v_and_b32 v43, 0xffff0000, v40
    v_and_b32 v52, 0xffff0000, v41
    v_lshlrev_b32 v41, 16, v41
    v_fma_f32 v48, v48, v44, v42
    v_fma_f32 v49, v49, v45, v43
    v_fma_f32 v50, v50, v46, v41
    v_fma_f32 v51, v51, v47, v52
    v_cvt_pk_bf16_f32 v40, v48, v49
    v_cvt_pk_bf16_f32 v41, v50, v51
    buffer_store_dwordx2 v[40:41], v7, s[56:59], 0 offen offset:96
    s_nop 1
    v_mov_b32 v40, v212
    v_mov_b32 v41, v213
    v_mov_b32 v44, v184
    v_mov_b32 v45, v185
    v_mov_b32 v46, v186
    v_mov_b32 v47, v187
    v_mov_b32 v48, v128
    v_mov_b32 v49, v129
    v_mov_b32 v50, v130
    v_mov_b32 v51, v131
    v_lshlrev_b32 v42, 16, v40
    v_and_b32 v43, 0xffff0000, v40
    v_and_b32 v52, 0xffff0000, v41
    v_lshlrev_b32 v41, 16, v41
    v_fma_f32 v48, v48, v44, v42
    v_fma_f32 v49, v49, v45, v43
    v_fma_f32 v50, v50, v46, v41
    v_fma_f32 v51, v51, v47, v52
    v_cvt_pk_bf16_f32 v40, v48, v49
    v_cvt_pk_bf16_f32 v41, v50, v51
    buffer_store_dwordx2 v[40:41], v7, s[56:59], 0 offen offset:128
    s_nop 1
    v_mov_b32 v40, v214
    v_mov_b32 v41, v215
    v_mov_b32 v44, v188
    v_mov_b32 v45, v189
    v_mov_b32 v46, v190
    v_mov_b32 v47, v191
    v_mov_b32 v48, v136
    v_mov_b32 v49, v137
    v_mov_b32 v50, v138
    v_mov_b32 v51, v139
    v_lshlrev_b32 v42, 16, v40
    v_and_b32 v43, 0xffff0000, v40
    v_and_b32 v52, 0xffff0000, v41
    v_lshlrev_b32 v41, 16, v41
    v_fma_f32 v48, v48, v44, v42
    v_fma_f32 v49, v49, v45, v43
    v_fma_f32 v50, v50, v46, v41
    v_fma_f32 v51, v51, v47, v52
    v_cvt_pk_bf16_f32 v40, v48, v49
    v_cvt_pk_bf16_f32 v41, v50, v51
    buffer_store_dwordx2 v[40:41], v7, s[56:59], 0 offen offset:160
    s_nop 1
    v_mov_b32 v40, v216
    v_mov_b32 v41, v217
    v_mov_b32 v44, v192
    v_mov_b32 v45, v193
    v_mov_b32 v46, v194
    v_mov_b32 v47, v195
    v_mov_b32 v48, v144
    v_mov_b32 v49, v145
    v_mov_b32 v50, v146
    v_mov_b32 v51, v147
    v_lshlrev_b32 v42, 16, v40
    v_and_b32 v43, 0xffff0000, v40
    v_and_b32 v52, 0xffff0000, v41
    v_lshlrev_b32 v41, 16, v41
    v_fma_f32 v48, v48, v44, v42
    v_fma_f32 v49, v49, v45, v43
    v_fma_f32 v50, v50, v46, v41
    v_fma_f32 v51, v51, v47, v52
    v_cvt_pk_bf16_f32 v40, v48, v49
    v_cvt_pk_bf16_f32 v41, v50, v51
    buffer_store_dwordx2 v[40:41], v7, s[56:59], 0 offen offset:192
    s_nop 1
    v_mov_b32 v40, v218
    v_mov_b32 v41, v219
    v_mov_b32 v44, v196
    v_mov_b32 v45, v197
    v_mov_b32 v46, v198
    v_mov_b32 v47, v199
    v_mov_b32 v48, v152
    v_mov_b32 v49, v153
    v_mov_b32 v50, v154
    v_mov_b32 v51, v155
    v_lshlrev_b32 v42, 16, v40
    v_and_b32 v43, 0xffff0000, v40
    v_and_b32 v52, 0xffff0000, v41
    v_lshlrev_b32 v41, 16, v41
    v_fma_f32 v48, v48, v44, v42
    v_fma_f32 v49, v49, v45, v43
    v_fma_f32 v50, v50, v46, v41
    v_fma_f32 v51, v51, v47, v52
    v_cvt_pk_bf16_f32 v40, v48, v49
    v_cvt_pk_bf16_f32 v41, v50, v51
    buffer_store_dwordx2 v[40:41], v7, s[56:59], 0 offen offset:224
    s_nop 1
    v_mov_b32 v40, v220
    v_mov_b32 v41, v221
    v_mov_b32 v44, v200
    v_mov_b32 v45, v201
    v_mov_b32 v46, v202
    v_mov_b32 v47, v203
    v_mov_b32 v48, v160
    v_mov_b32 v49, v161
    v_mov_b32 v50, v162
    v_mov_b32 v51, v163
    v_lshlrev_b32 v42, 16, v40
    v_and_b32 v43, 0xffff0000, v40
    v_and_b32 v52, 0xffff0000, v41
    v_lshlrev_b32 v41, 16, v41
    v_fma_f32 v48, v48, v44, v42
    v_fma_f32 v49, v49, v45, v43
    v_fma_f32 v50, v50, v46, v41
    v_fma_f32 v51, v51, v47, v52
    v_cvt_pk_bf16_f32 v40, v48, v49
    v_cvt_pk_bf16_f32 v41, v50, v51
    buffer_store_dwordx2 v[40:41], v7, s[56:59], 0 offen offset:256
    s_nop 1
    v_add_u32 v5, 16, v5
    v_add_u32 v7, 18432, v7
    buffer_load_dwordx2 v[204:205], v7, s[60:63], 0 offen offset:0
    buffer_load_dwordx2 v[206:207], v7, s[60:63], 0 offen offset:32
    buffer_load_dwordx2 v[208:209], v7, s[60:63], 0 offen offset:64
    buffer_load_dwordx2 v[210:211], v7, s[60:63], 0 offen offset:96
    buffer_load_dwordx2 v[212:213], v7, s[60:63], 0 offen offset:128
    buffer_load_dwordx2 v[214:215], v7, s[60:63], 0 offen offset:160
    buffer_load_dwordx2 v[216:217], v7, s[60:63], 0 offen offset:192
    buffer_load_dwordx2 v[218:219], v7, s[60:63], 0 offen offset:224
    buffer_load_dwordx2 v[220:221], v7, s[60:63], 0 offen offset:256
    s_waitcnt vmcnt(0)
    v_mov_b32 v60, 0
    v_mov_b32 v61, 0
    v_mov_b32 v40, v204
    v_mov_b32 v41, v205
    v_mov_b32 v44, v168
    v_mov_b32 v45, v169
    v_mov_b32 v46, v170
    v_mov_b32 v47, v171
    v_mov_b32 v48, v100
    v_mov_b32 v49, v101
    v_mov_b32 v50, v102
    v_mov_b32 v51, v103
    v_lshlrev_b32 v42, 16, v40
    v_and_b32 v43, 0xffff0000, v40
    v_and_b32 v52, 0xffff0000, v41
    v_lshlrev_b32 v41, 16, v41
    v_fma_f32 v48, v48, v44, v42
    v_fma_f32 v49, v49, v45, v43
    v_fma_f32 v50, v50, v46, v41
    v_fma_f32 v51, v51, v47, v52
    v_cvt_pk_bf16_f32 v40, v48, v49
    v_cvt_pk_bf16_f32 v41, v50, v51
    buffer_store_dwordx2 v[40:41], v7, s[56:59], 0 offen offset:0
    s_nop 1
    v_mov_b32 v40, v206
    v_mov_b32 v41, v207
    v_mov_b32 v44, v172
    v_mov_b32 v45, v173
    v_mov_b32 v46, v174
    v_mov_b32 v47, v175
    v_mov_b32 v48, v108
    v_mov_b32 v49, v109
    v_mov_b32 v50, v110
    v_mov_b32 v51, v111
    v_lshlrev_b32 v42, 16, v40
    v_and_b32 v43, 0xffff0000, v40
    v_and_b32 v52, 0xffff0000, v41
    v_lshlrev_b32 v41, 16, v41
    v_fma_f32 v48, v48, v44, v42
    v_fma_f32 v49, v49, v45, v43
    v_fma_f32 v50, v50, v46, v41
    v_fma_f32 v51, v51, v47, v52
    v_cvt_pk_bf16_f32 v40, v48, v49
    v_cvt_pk_bf16_f32 v41, v50, v51
    buffer_store_dwordx2 v[40:41], v7, s[56:59], 0 offen offset:32
    s_nop 1
    v_mov_b32 v40, v208
    v_mov_b32 v41, v209
    v_mov_b32 v44, v176
    v_mov_b32 v45, v177
    v_mov_b32 v46, v178
    v_mov_b32 v47, v179
    v_mov_b32 v48, v116
    v_mov_b32 v49, v117
    v_mov_b32 v50, v118
    v_mov_b32 v51, v119
    v_lshlrev_b32 v42, 16, v40
    v_and_b32 v43, 0xffff0000, v40
    v_and_b32 v52, 0xffff0000, v41
    v_lshlrev_b32 v41, 16, v41
    v_fma_f32 v48, v48, v44, v42
    v_fma_f32 v49, v49, v45, v43
    v_fma_f32 v50, v50, v46, v41
    v_fma_f32 v51, v51, v47, v52
    v_cvt_pk_bf16_f32 v40, v48, v49
    v_cvt_pk_bf16_f32 v41, v50, v51
    buffer_store_dwordx2 v[40:41], v7, s[56:59], 0 offen offset:64
    s_nop 1
    v_mov_b32 v40, v210
    v_mov_b32 v41, v211
    v_mov_b32 v44, v180
    v_mov_b32 v45, v181
    v_mov_b32 v46, v182
    v_mov_b32 v47, v183
    v_mov_b32 v48, v124
    v_mov_b32 v49, v125
    v_mov_b32 v50, v126
    v_mov_b32 v51, v127
    v_lshlrev_b32 v42, 16, v40
    v_and_b32 v43, 0xffff0000, v40
    v_and_b32 v52, 0xffff0000, v41
    v_lshlrev_b32 v41, 16, v41
    v_fma_f32 v48, v48, v44, v42
    v_fma_f32 v49, v49, v45, v43
    v_fma_f32 v50, v50, v46, v41
    v_fma_f32 v51, v51, v47, v52
    v_cvt_pk_bf16_f32 v40, v48, v49
    v_cvt_pk_bf16_f32 v41, v50, v51
    buffer_store_dwordx2 v[40:41], v7, s[56:59], 0 offen offset:96
    s_nop 1
    v_mov_b32 v40, v212
    v_mov_b32 v41, v213
    v_mov_b32 v44, v184
    v_mov_b32 v45, v185
    v_mov_b32 v46, v186
    v_mov_b32 v47, v187
    v_mov_b32 v48, v132
    v_mov_b32 v49, v133
    v_mov_b32 v50, v134
    v_mov_b32 v51, v135
    v_lshlrev_b32 v42, 16, v40
    v_and_b32 v43, 0xffff0000, v40
    v_and_b32 v52, 0xffff0000, v41
    v_lshlrev_b32 v41, 16, v41
    v_fma_f32 v48, v48, v44, v42
    v_fma_f32 v49, v49, v45, v43
    v_fma_f32 v50, v50, v46, v41
    v_fma_f32 v51, v51, v47, v52
    v_cvt_pk_bf16_f32 v40, v48, v49
    v_cvt_pk_bf16_f32 v41, v50, v51
    buffer_store_dwordx2 v[40:41], v7, s[56:59], 0 offen offset:128
    s_nop 1
    v_mov_b32 v40, v214
    v_mov_b32 v41, v215
    v_mov_b32 v44, v188
    v_mov_b32 v45, v189
    v_mov_b32 v46, v190
    v_mov_b32 v47, v191
    v_mov_b32 v48, v140
    v_mov_b32 v49, v141
    v_mov_b32 v50, v142
    v_mov_b32 v51, v143
    v_lshlrev_b32 v42, 16, v40
    v_and_b32 v43, 0xffff0000, v40
    v_and_b32 v52, 0xffff0000, v41
    v_lshlrev_b32 v41, 16, v41
    v_fma_f32 v48, v48, v44, v42
    v_fma_f32 v49, v49, v45, v43
    v_fma_f32 v50, v50, v46, v41
    v_fma_f32 v51, v51, v47, v52
    v_cvt_pk_bf16_f32 v40, v48, v49
    v_cvt_pk_bf16_f32 v41, v50, v51
    buffer_store_dwordx2 v[40:41], v7, s[56:59], 0 offen offset:160
    s_nop 1
    v_mov_b32 v40, v216
    v_mov_b32 v41, v217
    v_mov_b32 v44, v192
    v_mov_b32 v45, v193
    v_mov_b32 v46, v194
    v_mov_b32 v47, v195
    v_mov_b32 v48, v148
    v_mov_b32 v49, v149
    v_mov_b32 v50, v150
    v_mov_b32 v51, v151
    v_lshlrev_b32 v42, 16, v40
    v_and_b32 v43, 0xffff0000, v40
    v_and_b32 v52, 0xffff0000, v41
    v_lshlrev_b32 v41, 16, v41
    v_fma_f32 v48, v48, v44, v42
    v_fma_f32 v49, v49, v45, v43
    v_fma_f32 v50, v50, v46, v41
    v_fma_f32 v51, v51, v47, v52
    v_cvt_pk_bf16_f32 v40, v48, v49
    v_cvt_pk_bf16_f32 v41, v50, v51
    buffer_store_dwordx2 v[40:41], v7, s[56:59], 0 offen offset:192
    s_nop 1
    v_mov_b32 v40, v218
    v_mov_b32 v41, v219
    v_mov_b32 v44, v196
    v_mov_b32 v45, v197
    v_mov_b32 v46, v198
    v_mov_b32 v47, v199
    v_mov_b32 v48, v156
    v_mov_b32 v49, v157
    v_mov_b32 v50, v158
    v_mov_b32 v51, v159
    v_lshlrev_b32 v42, 16, v40
    v_and_b32 v43, 0xffff0000, v40
    v_and_b32 v52, 0xffff0000, v41
    v_lshlrev_b32 v41, 16, v41
    v_fma_f32 v48, v48, v44, v42
    v_fma_f32 v49, v49, v45, v43
    v_fma_f32 v50, v50, v46, v41
    v_fma_f32 v51, v51, v47, v52
    v_cvt_pk_bf16_f32 v40, v48, v49
    v_cvt_pk_bf16_f32 v41, v50, v51
    buffer_store_dwordx2 v[40:41], v7, s[56:59], 0 offen offset:224
    s_nop 1
    v_mov_b32 v40, v220
    v_mov_b32 v41, v221
    v_mov_b32 v44, v200
    v_mov_b32 v45, v201
    v_mov_b32 v46, v202
    v_mov_b32 v47, v203
    v_mov_b32 v48, v164
    v_mov_b32 v49, v165
    v_mov_b32 v50, v166
    v_mov_b32 v51, v167
    v_lshlrev_b32 v42, 16, v40
    v_and_b32 v43, 0xffff0000, v40
    v_and_b32 v52, 0xffff0000, v41
    v_lshlrev_b32 v41, 16, v41
    v_fma_f32 v48, v48, v44, v42
    v_fma_f32 v49, v49, v45, v43
    v_fma_f32 v50, v50, v46, v41
    v_fma_f32 v51, v51, v47, v52
    v_cvt_pk_bf16_f32 v40, v48, v49
    v_cvt_pk_bf16_f32 v41, v50, v51
    buffer_store_dwordx2 v[40:41], v7, s[56:59], 0 offen offset:256
    s_nop 1
    v_add_u32 v5, 16, v5
    v_add_u32 v7, 18432, v7
k3_end:
    s_endpgm

.globl ln2_kernel
.p2align 8
.type ln2_kernel,@function
ln2_kernel:
    s_cmp_ge_u32 s2, 512
    s_cbranch_scc1 ln2_kernel_end
    s_load_dwordx2 s[4:5], s[0:1], 88
    s_load_dwordx2 s[8:9], s[0:1], 88
    s_waitcnt lgkmcnt(0)
    s_add_u32 s12, s4, 0x1000000
    s_addc_u32 s13, s5, 0
    s_and_b32 s13, s13, 0xffff
    s_mov_b32 s14, 0x240000
    s_mov_b32 s15, 0x00020000
    s_add_u32 s16, s8, 0x3c00000
    s_addc_u32 s17, s9, 0
    s_and_b32 s17, s17, 0xffff
    s_mov_b32 s18, 0x240000
    s_mov_b32 s19, 0x00020000
    s_mov_b32 s20, s8
    s_mov_b32 s21, s9
    s_and_b32 s21, s21, 0xffff
    s_mov_b32 s22, 0x4000
    s_mov_b32 s23, 0x00020000
    v_lshrrev_b32 v1, 6, v0
    v_and_b32 v3, 63, v0
    s_lshl_b32 s24, s2, 2
    v_add_u32 v4, s24, v1
    s_mov_b32 s25, 1152
    v_mul_lo_u32 v5, v4, s25
    v_lshlrev_b32 v6, 4, v3
    v_add_u32 v5, v5, v6
    v_lshlrev_b32 v7, 5, v3
    v_mov_b32 v24, 0
    v_mov_b32 v25, 0
    v_mov_b32 v26, 0
    v_mov_b32 v27, 0
    buffer_load_dwordx4 v[20:23], v5, s[12:15], 0 offen
    v_add_u32 v8, 9216, v7
    v_add_u32 v9, 6912, v7
    buffer_load_dwordx4 v[32:35], v8, s[20:23], 0 offen
    buffer_load_dwordx4 v[36:39], v8, s[20:23], 0 offen offset:16
    buffer_load_dwordx4 v[40:43], v9, s[20:23], 0 offen
    buffer_load_dwordx4 v[44:47], v9, s[20:23], 0 offen offset:16
    v_cmp_gt_u32 vcc, 8, v3
    s_and_saveexec_b64 s[26:27], vcc
    buffer_load_dwordx4 v[24:27], v5, s[12:15], 0 offen offset:1024
    buffer_load_dwordx4 v[48:51], v8, s[20:23], 0 offen offset:2048
    buffer_load_dwordx4 v[52:55], v8, s[20:23], 0 offen offset:2064
    buffer_load_dwordx4 v[56:59], v9, s[20:23], 0 offen offset:2048
    buffer_load_dwordx4 v[60:63], v9, s[20:23], 0 offen offset:2064
    s_mov_b64 exec, s[26:27]
    s_waitcnt vmcnt(0)
    v_mov_b32 v10, 0
    v_mov_b32 v11, 0
    v_lshlrev_b32 v12, 16, v20
    v_and_b32 v13, 0xffff0000, v20
    v_add_f32 v10, v10, v12
    v_fmac_f32 v11, v12, v12
    v_add_f32 v10, v10, v13
    v_fmac_f32 v11, v13, v13
    v_lshlrev_b32 v12, 16, v21
    v_and_b32 v13, 0xffff0000, v21
    v_add_f32 v10, v10, v12
    v_fmac_f32 v11, v12, v12
    v_add_f32 v10, v10, v13
    v_fmac_f32 v11, v13, v13
    v_lshlrev_b32 v12, 16, v22
    v_and_b32 v13, 0xffff0000, v22
    v_add_f32 v10, v10, v12
    v_fmac_f32 v11, v12, v12
    v_add_f32 v10, v10, v13
    v_fmac_f32 v11, v13, v13
    v_lshlrev_b32 v12, 16, v23
    v_and_b32 v13, 0xffff0000, v23
    v_add_f32 v10, v10, v12
    v_fmac_f32 v11, v12, v12
    v_add_f32 v10, v10, v13
    v_fmac_f32 v11, v13, v13
    v_lshlrev_b32 v12, 16, v24
    v_and_b32 v13, 0xffff0000, v24
    v_add_f32 v10, v10, v12
    v_fmac_f32 v11, v12, v12
    v_add_f32 v10, v10, v13
    v_fmac_f32 v11, v13, v13
    v_lshlrev_b32 v12, 16, v25
    v_and_b32 v13, 0xffff0000, v25
    v_add_f32 v10, v10, v12
    v_fmac_f32 v11, v12, v12
    v_add_f32 v10, v10, v13
    v_fmac_f32 v11, v13, v13
    v_lshlrev_b32 v12, 16, v26
    v_and_b32 v13, 0xffff0000, v26
    v_add_f32 v10, v10, v12
    v_fmac_f32 v11, v12, v12
    v_add_f32 v10, v10, v13
    v_fmac_f32 v11, v13, v13
    v_lshlrev_b32 v12, 16, v27
    v_and_b32 v13, 0xffff0000, v27
    v_add_f32 v10, v10, v12
    v_fmac_f32 v11, v12, v12
    v_add_f32 v10, v10, v13
    v_fmac_f32 v11, v13, v13
    v_mov_b32 v31, v3
    v_xor_b32 v30, 1, v31
    v_lshlrev_b32 v30, 2, v30
    ds_bpermute_b32 v14, v30, v10
    ds_bpermute_b32 v15, v30, v11
    s_waitcnt lgkmcnt(0)
    v_add_f32 v10, v10, v14
    v_add_f32 v11, v11, v15
    v_xor_b32 v30, 2, v31
    v_lshlrev_b32 v30, 2, v30
    ds_bpermute_b32 v14, v30, v10
    ds_bpermute_b32 v15, v30, v11
    s_waitcnt lgkmcnt(0)
    v_add_f32 v10, v10, v14
    v_add_f32 v11, v11, v15
    v_xor_b32 v30, 4, v31
    v_lshlrev_b32 v30, 2, v30
    ds_bpermute_b32 v14, v30, v10
    ds_bpermute_b32 v15, v30, v11
    s_waitcnt lgkmcnt(0)
    v_add_f32 v10, v10, v14
    v_add_f32 v11, v11, v15
    v_xor_b32 v30, 8, v31
    v_lshlrev_b32 v30, 2, v30
    ds_bpermute_b32 v14, v30, v10
    ds_bpermute_b32 v15, v30, v11
    s_waitcnt lgkmcnt(0)
    v_add_f32 v10, v10, v14
    v_add_f32 v11, v11, v15
    v_xor_b32 v30, 16, v31
    v_lshlrev_b32 v30, 2, v30
    ds_bpermute_b32 v14, v30, v10
    ds_bpermute_b32 v15, v30, v11
    s_waitcnt lgkmcnt(0)
    v_add_f32 v10, v10, v14
    v_add_f32 v11, v11, v15
    v_xor_b32 v30, 32, v31
    v_lshlrev_b32 v30, 2, v30
    ds_bpermute_b32 v14, v30, v10
    ds_bpermute_b32 v15, v30, v11
    s_waitcnt lgkmcnt(0)
    v_add_f32 v10, v10, v14
    v_add_f32 v11, v11, v15
    v_mul_f32 v10, 0.001736111111111111, v10
    v_mul_f32 v11, 0.001736111111111111, v11
    v_fma_f32 v11, -v10, v10, v11
    v_add_f32 v11, 0x3727c5ac, v11
    v_rsq_f32 v11, v11
    s_nop 0
    v_mul_f32 v10, v10, v11
    v_sub_f32 v10, 0, v10
    v_lshlrev_b32 v12, 16, v20
    v_and_b32 v13, 0xffff0000, v20
    v_fma_f32 v12, v12, v11, v10
    v_fma_f32 v13, v13, v11, v10
    v_add_f32 v14, 1.0, v32
    v_add_f32 v15, 1.0, v33
    v_fma_f32 v12, v12, v14, v40
    v_fma_f32 v13, v13, v15, v41
    v_cvt_pk_bf16_f32 v20, v12, v13
    v_lshlrev_b32 v12, 16, v21
    v_and_b32 v13, 0xffff0000, v21
    v_fma_f32 v12, v12, v11, v10
    v_fma_f32 v13, v13, v11, v10
    v_add_f32 v14, 1.0, v34
    v_add_f32 v15, 1.0, v35
    v_fma_f32 v12, v12, v14, v42
    v_fma_f32 v13, v13, v15, v43
    v_cvt_pk_bf16_f32 v21, v12, v13
    v_lshlrev_b32 v12, 16, v22
    v_and_b32 v13, 0xffff0000, v22
    v_fma_f32 v12, v12, v11, v10
    v_fma_f32 v13, v13, v11, v10
    v_add_f32 v14, 1.0, v36
    v_add_f32 v15, 1.0, v37
    v_fma_f32 v12, v12, v14, v44
    v_fma_f32 v13, v13, v15, v45
    v_cvt_pk_bf16_f32 v22, v12, v13
    v_lshlrev_b32 v12, 16, v23
    v_and_b32 v13, 0xffff0000, v23
    v_fma_f32 v12, v12, v11, v10
    v_fma_f32 v13, v13, v11, v10
    v_add_f32 v14, 1.0, v38
    v_add_f32 v15, 1.0, v39
    v_fma_f32 v12, v12, v14, v46
    v_fma_f32 v13, v13, v15, v47
    v_cvt_pk_bf16_f32 v23, v12, v13
    v_lshlrev_b32 v12, 16, v24
    v_and_b32 v13, 0xffff0000, v24
    v_fma_f32 v12, v12, v11, v10
    v_fma_f32 v13, v13, v11, v10
    v_add_f32 v14, 1.0, v48
    v_add_f32 v15, 1.0, v49
    v_fma_f32 v12, v12, v14, v56
    v_fma_f32 v13, v13, v15, v57
    v_cvt_pk_bf16_f32 v24, v12, v13
    v_lshlrev_b32 v12, 16, v25
    v_and_b32 v13, 0xffff0000, v25
    v_fma_f32 v12, v12, v11, v10
    v_fma_f32 v13, v13, v11, v10
    v_add_f32 v14, 1.0, v50
    v_add_f32 v15, 1.0, v51
    v_fma_f32 v12, v12, v14, v58
    v_fma_f32 v13, v13, v15, v59
    v_cvt_pk_bf16_f32 v25, v12, v13
    v_lshlrev_b32 v12, 16, v26
    v_and_b32 v13, 0xffff0000, v26
    v_fma_f32 v12, v12, v11, v10
    v_fma_f32 v13, v13, v11, v10
    v_add_f32 v14, 1.0, v52
    v_add_f32 v15, 1.0, v53
    v_fma_f32 v12, v12, v14, v60
    v_fma_f32 v13, v13, v15, v61
    v_cvt_pk_bf16_f32 v26, v12, v13
    v_lshlrev_b32 v12, 16, v27
    v_and_b32 v13, 0xffff0000, v27
    v_fma_f32 v12, v12, v11, v10
    v_fma_f32 v13, v13, v11, v10
    v_add_f32 v14, 1.0, v54
    v_add_f32 v15, 1.0, v55
    v_fma_f32 v12, v12, v14, v62
    v_fma_f32 v13, v13, v15, v63
    v_cvt_pk_bf16_f32 v27, v12, v13
    buffer_store_dwordx4 v[20:23], v5, s[16:19], 0 offen
    v_cmp_gt_u32 vcc, 8, v3
    s_and_saveexec_b64 s[26:27], vcc
    buffer_store_dwordx4 v[24:27], v5, s[16:19], 0 offen offset:1024
ln2_kernel_end:
    s_endpgm

.globl k4_kernel
.p2align 8
.type k4_kernel,@function
k4_kernel:
    s_cmp_ge_u32 s2, 256
    s_cbranch_scc1 k4_end
    s_load_dwordx2 s[4:5], s[0:1], 32
    s_load_dwordx2 s[6:7], s[0:1], 40
    s_load_dwordx2 s[8:9], s[0:1], 88
    s_waitcnt lgkmcnt(0)
    s_add_u32 s40, s8, 0x3c00000
    s_addc_u32 s41, s9, 0
    s_and_b32 s41, s41, 0xffff
    s_mov_b32 s42, 0x240000
    s_mov_b32 s43, 0x00020000
    s_mov_b32 s44, s4
    s_mov_b32 s45, s5
    s_and_b32 s45, s45, 0xffff
    s_mov_b32 s46, 0x510000
    s_mov_b32 s47, 0x00020000
    s_mov_b32 s48, s6
    s_mov_b32 s49, s7
    s_and_b32 s49, s49, 0xffff
    s_mov_b32 s50, 0x510000
    s_mov_b32 s51, 0x00020000
    s_mov_b32 s52, s8
    s_mov_b32 s53, s9
    s_and_b32 s53, s53, 0xffff
    s_mov_b32 s54, 0x20000
    s_mov_b32 s55, 0x00020000
    s_add_u32 s56, s8, 0x1400000
    s_addc_u32 s57, s9, 0
    s_and_b32 s57, s57, 0xffff
    s_mov_b32 s58, 0x1200000
    s_mov_b32 s59, 0x00020000
    s_and_b32 s10, s2, 7
    s_lshr_b32 s11, s2, 3
    s_lshl_b32 s20, s10, 8
    s_mul_i32 s21, s11, 144
    s_mov_b32 s22, 0
    v_and_b32 v1, 63, v0
    v_lshrrev_b32 v2, 6, v0
    s_nop 0
    v_readfirstlane_b32 s23, v2
    s_mov_b32 s24, 0
    s_mov_b32 s25, s23
    s_mov_b32 s26, 1152
    s_mul_i32 s27, s23, 64
    v_lshrrev_b32 v3, 3, v1
    v_add_u32 v3, 0, v3
    v_add_u32 v3, s27, v3
    v_lshrrev_b32 v4, 1, v3
    v_and_b32 v4, 7, v4
    v_and_b32 v5, 7, v1
    v_xor_b32 v4, v4, v5
    v_add_u32 v3, s20, v3
    v_mul_lo_u32 v8, v3, s26
    v_lshlrev_b32 v4, 4, v4
    v_add_u32 v8, v8, v4
    v_lshrrev_b32 v3, 3, v1
    v_add_u32 v3, 8, v3
    v_add_u32 v3, s27, v3
    v_lshrrev_b32 v4, 1, v3
    v_and_b32 v4, 7, v4
    v_and_b32 v5, 7, v1
    v_xor_b32 v4, v4, v5
    v_add_u32 v3, s20, v3
    v_mul_lo_u32 v9, v3, s26
    v_lshlrev_b32 v4, 4, v4
    v_add_u32 v9, v9, v4
    v_lshrrev_b32 v3, 3, v1
    v_add_u32 v3, 16, v3
    v_add_u32 v3, s27, v3
    v_lshrrev_b32 v4, 1, v3
    v_and_b32 v4, 7, v4
    v_and_b32 v5, 7, v1
    v_xor_b32 v4, v4, v5
    v_add_u32 v3, s20, v3
    v_mul_lo_u32 v10, v3, s26
    v_lshlrev_b32 v4, 4, v4
    v_add_u32 v10, v10, v4
    v_lshrrev_b32 v3, 3, v1
    v_add_u32 v3, 24, v3
    v_add_u32 v3, s27, v3
    v_lshrrev_b32 v4, 1, v3
    v_and_b32 v4, 7, v4
    v_and_b32 v5, 7, v1
    v_xor_b32 v4, v4, v5
    v_add_u32 v3, s20, v3
    v_mul_lo_u32 v11, v3, s26
    v_lshlrev_b32 v4, 4, v4
    v_add_u32 v11, v11, v4
    v_lshrrev_b32 v3, 3, v1
    v_add_u32 v3, 32, v3
    v_add_u32 v3, s27, v3
    v_lshrrev_b32 v4, 1, v3
    v_and_b32 v4, 7, v4
    v_and_b32 v5, 7, v1
    v_xor_b32 v4, v4, v5
    v_add_u32 v3, s20, v3
    v_mul_lo_u32 v12, v3, s26
    v_lshlrev_b32 v4, 4, v4
    v_add_u32 v12, v12, v4
    v_lshrrev_b32 v3, 3, v1
    v_add_u32 v3, 40, v3
    v_add_u32 v3, s27, v3
    v_lshrrev_b32 v4, 1, v3
    v_and_b32 v4, 7, v4
    v_and_b32 v5, 7, v1
    v_xor_b32 v4, v4, v5
    v_add_u32 v3, s20, v3
    v_mul_lo_u32 v13, v3, s26
    v_lshlrev_b32 v4, 4, v4
    v_add_u32 v13, v13, v4
    v_lshrrev_b32 v3, 3, v1
    v_add_u32 v3, 48, v3
    v_add_u32 v3, s27, v3
    v_lshrrev_b32 v4, 1, v3
    v_and_b32 v4, 7, v4
    v_and_b32 v5, 7, v1
    v_xor_b32 v4, v4, v5
    v_add_u32 v3, s20, v3
    v_mul_lo_u32 v14, v3, s26
    v_lshlrev_b32 v4, 4, v4
    v_add_u32 v14, v14, v4
    v_lshrrev_b32 v3, 3, v1
    v_add_u32 v3, 56, v3
    v_add_u32 v3, s27, v3
    v_lshrrev_b32 v4, 1, v3
    v_and_b32 v4, 7, v4
    v_and_b32 v5, 7, v1
    v_xor_b32 v4, v4, v5
    v_add_u32 v3, s20, v3
    v_mul_lo_u32 v15, v3, s26
    v_lshlrev_b32 v4, 4, v4
    v_add_u32 v15, v15, v4
    s_mov_b32 s27, 9216
    s_lshl_b32 s28, s21, 1
    s_add_u32 s29, s23, 0
    s_min_u32 s29, s29, 17
    s_lshl_b32 s29, s29, 6
    v_add_u32 v5, s29, v1
    s_mov_b32 s29, 3641
    v_mul_lo_u32 v6, v5, s29
    v_lshrrev_b32 v6, 16, v6
    v_mul_u32_u24 v7, 18, v6
    v_sub_u32 v7, v5, v7
    v_and_b32 v3, 32, v6
    v_bfe_u32 v4, v6, 4, 1
    v_lshlrev_b32 v4, 2, v4
    v_add_u32 v3, v3, v4
    v_bfe_u32 v4, v6, 2, 2
    v_lshlrev_b32 v4, 3, v4
    v_add_u32 v3, v3, v4
    v_and_b32 v4, 3, v6
    v_add_u32 v3, v3, v4
    v_mul_lo_u32 v17, v3, s27
    v_lshlrev_b32 v7, 4, v7
    v_add_u32 v17, v17, v7
    v_add_u32 v17, s28, v17
    s_add_u32 s29, s23, 4
    s_min_u32 s29, s29, 17
    s_lshl_b32 s29, s29, 6
    v_add_u32 v5, s29, v1
    s_mov_b32 s29, 3641
    v_mul_lo_u32 v6, v5, s29
    v_lshrrev_b32 v6, 16, v6
    v_mul_u32_u24 v7, 18, v6
    v_sub_u32 v7, v5, v7
    v_and_b32 v3, 32, v6
    v_bfe_u32 v4, v6, 4, 1
    v_lshlrev_b32 v4, 2, v4
    v_add_u32 v3, v3, v4
    v_bfe_u32 v4, v6, 2, 2
    v_lshlrev_b32 v4, 3, v4
    v_add_u32 v3, v3, v4
    v_and_b32 v4, 3, v6
    v_add_u32 v3, v3, v4
    v_mul_lo_u32 v18, v3, s27
    v_lshlrev_b32 v7, 4, v7
    v_add_u32 v18, v18, v7
    v_add_u32 v18, s28, v18
    s_add_u32 s29, s23, 8
    s_min_u32 s29, s29, 17
    s_lshl_b32 s29, s29, 6
    v_add_u32 v5, s29, v1
    s_mov_b32 s29, 3641
    v_mul_lo_u32 v6, v5, s29
    v_lshrrev_b32 v6, 16, v6
    v_mul_u32_u24 v7, 18, v6
    v_sub_u32 v7, v5, v7
    v_and_b32 v3, 32, v6
    v_bfe_u32 v4, v6, 4, 1
    v_lshlrev_b32 v4, 2, v4
    v_add_u32 v3, v3, v4
    v_bfe_u32 v4, v6, 2, 2
    v_lshlrev_b32 v4, 3, v4
    v_add_u32 v3, v3, v4
    v_and_b32 v4, 3, v6
    v_add_u32 v3, v3, v4
    v_mul_lo_u32 v19, v3, s27
    v_lshlrev_b32 v7, 4, v7
    v_add_u32 v19, v19, v7
    v_add_u32 v19, s28, v19
    s_add_u32 s29, s23, 12
    s_min_u32 s29, s29, 17
    s_lshl_b32 s29, s29, 6
    v_add_u32 v5, s29, v1
    s_mov_b32 s29, 3641
    v_mul_lo_u32 v6, v5, s29
    v_lshrrev_b32 v6, 16, v6
    v_mul_u32_u24 v7, 18, v6
    v_sub_u32 v7, v5, v7
    v_and_b32 v3, 32, v6
    v_bfe_u32 v4, v6, 4, 1
    v_lshlrev_b32 v4, 2, v4
    v_add_u32 v3, v3, v4
    v_bfe_u32 v4, v6, 2, 2
    v_lshlrev_b32 v4, 3, v4
    v_add_u32 v3, v3, v4
    v_and_b32 v4, 3, v6
    v_add_u32 v3, v3, v4
    v_mul_lo_u32 v20, v3, s27
    v_lshlrev_b32 v7, 4, v7
    v_add_u32 v20, v20, v7
    v_add_u32 v20, s28, v20
    s_add_u32 s29, s23, 16
    s_min_u32 s29, s29, 17
    s_lshl_b32 s29, s29, 6
    v_add_u32 v5, s29, v1
    s_mov_b32 s29, 3641
    v_mul_lo_u32 v6, v5, s29
    v_lshrrev_b32 v6, 16, v6
    v_mul_u32_u24 v7, 18, v6
    v_sub_u32 v7, v5, v7
    v_and_b32 v3, 32, v6
    v_bfe_u32 v4, v6, 4, 1
    v_lshlrev_b32 v4, 2, v4
    v_add_u32 v3, v3, v4
    v_bfe_u32 v4, v6, 2, 2
    v_lshlrev_b32 v4, 3, v4
    v_add_u32 v3, v3, v4
    v_and_b32 v4, 3, v6
    v_add_u32 v3, v3, v4
    v_mul_lo_u32 v21, v3, s27
    v_lshlrev_b32 v7, 4, v7
    v_add_u32 v21, v21, v7
    v_add_u32 v21, s28, v21
    v_and_b32 v5, 15, v1
    v_lshrrev_b32 v6, 4, v1
    v_lshrrev_b32 v7, 1, v5
    v_xor_b32 v7, v7, v6
    s_lshl_b32 s26, s25, 13
    v_lshlrev_b32 v27, 7, v5
    v_add_u32 v27, s26, v27
    v_xor_b32 v28, 4, v7
    v_lshlrev_b32 v28, 4, v28
    v_add_u32 v28, v27, v28
    v_lshlrev_b32 v7, 4, v7
    v_add_u32 v27, v27, v7
    v_and_b32 v5, 15, v1
    v_lshrrev_b32 v6, 4, v1
    v_lshrrev_b32 v7, 2, v5
    v_lshlrev_b32 v31, 2, v6
    v_add_u32 v31, v31, v7
    v_mul_u32_u24 v31, 288, v31
    v_and_b32 v5, 3, v5
    v_lshlrev_b32 v5, 3, v5
    v_add_u32 v31, v31, v5
    v_add_u32 v31, 32768, v31
    s_mov_b32 s70, 0
    s_mov_b32 s71, 0
    s_mov_b32 s73, 0
    s_min_u32 s72, s70, 8
    s_lshl_b32 s30, s72, 6
    s_add_u32 s30, s30, s22
    s_mul_i32 s31, s30, 9216
    s_lshl_b32 s30, s30, 1
    s_mul_i32 s32, s23, 8192
    s_add_u32 s32, s32, s71
    s_add_u32 m0, s32, 0
    s_nop 0
    buffer_load_dwordx4 v8, s[40:43], s30 offen lds
    s_add_u32 m0, s32, 1024
    s_nop 0
    buffer_load_dwordx4 v9, s[40:43], s30 offen lds
    s_add_u32 m0, s32, 2048
    s_nop 0
    buffer_load_dwordx4 v10, s[40:43], s30 offen lds
    s_add_u32 m0, s32, 3072
    s_nop 0
    buffer_load_dwordx4 v11, s[40:43], s30 offen lds
    s_add_u32 m0, s32, 4096
    s_nop 0
    buffer_load_dwordx4 v12, s[40:43], s30 offen lds
    s_add_u32 m0, s32, 5120
    s_nop 0
    buffer_load_dwordx4 v13, s[40:43], s30 offen lds
    s_add_u32 m0, s32, 6144
    s_nop 0
    buffer_load_dwordx4 v14, s[40:43], s30 offen lds
    s_add_u32 m0, s32, 7168
    s_nop 0
    buffer_load_dwordx4 v15, s[40:43], s30 offen lds
    s_add_u32 s33, s23, 0
    s_min_u32 s33, s33, 17
    s_lshl_b32 s33, s33, 10
    s_add_u32 s33, s33, s71
    s_add_u32 m0, s33, 32768
    s_nop 0
    buffer_load_dwordx4 v17, s[44:47], s31 offen lds
    s_add_u32 s33, s23, 4
    s_min_u32 s33, s33, 17
    s_lshl_b32 s33, s33, 10
    s_add_u32 s33, s33, s71
    s_add_u32 m0, s33, 32768
    s_nop 0
    buffer_load_dwordx4 v18, s[44:47], s31 offen lds
    s_add_u32 s33, s23, 8
    s_min_u32 s33, s33, 17
    s_lshl_b32 s33, s33, 10
    s_add_u32 s33, s33, s71
    s_add_u32 m0, s33, 32768
    s_nop 0
    buffer_load_dwordx4 v19, s[44:47], s31 offen lds
    s_add_u32 s33, s23, 12
    s_min_u32 s33, s33, 17
    s_lshl_b32 s33, s33, 10
    s_add_u32 s33, s33, s71
    s_add_u32 m0, s33, 32768
    s_nop 0
    buffer_load_dwordx4 v20, s[44:47], s31 offen lds
    s_add_u32 s33, s23, 16
    s_min_u32 s33, s33, 17
    s_lshl_b32 s33, s33, 10
    s_add_u32 s33, s33, s71
    s_add_u32 m0, s33, 32768
    s_nop 0
    buffer_load_dwordx4 v21, s[44:47], s31 offen lds
    s_add_u32 s33, s23, 0
    s_min_u32 s33, s33, 17
    s_lshl_b32 s33, s33, 10
    s_add_u32 s33, s33, s71
    s_add_u32 m0, s33, 51200
    s_nop 0
    buffer_load_dwordx4 v17, s[48:51], s31 offen lds
    s_add_u32 s33, s23, 4
    s_min_u32 s33, s33, 17
    s_lshl_b32 s33, s33, 10
    s_add_u32 s33, s33, s71
    s_add_u32 m0, s33, 51200
    s_nop 0
    buffer_load_dwordx4 v18, s[48:51], s31 offen lds
    s_add_u32 s33, s23, 8
    s_min_u32 s33, s33, 17
    s_lshl_b32 s33, s33, 10
    s_add_u32 s33, s33, s71
    s_add_u32 m0, s33, 51200
    s_nop 0
    buffer_load_dwordx4 v19, s[48:51], s31 offen lds
    s_add_u32 s33, s23, 12
    s_min_u32 s33, s33, 17
    s_lshl_b32 s33, s33, 10
    s_add_u32 s33, s33, s71
    s_add_u32 m0, s33, 51200
    s_nop 0
    buffer_load_dwordx4 v20, s[48:51], s31 offen lds
    s_add_u32 s33, s23, 16
    s_min_u32 s33, s33, 17
    s_lshl_b32 s33, s33, 10
    s_add_u32 s33, s33, s71
    s_add_u32 m0, s33, 51200
    s_nop 0
    buffer_load_dwordx4 v21, s[48:51], s31 offen lds
    s_add_u32 s70, s70, 1
    s_add_u32 s71, s71, 69632
    s_cmp_ge_u32 s71, 139264
    s_cselect_b32 s71, 0, s71
    v_accvgpr_write_b32 a0, 0
    v_accvgpr_write_b32 a1, 0
    v_accvgpr_write_b32 a2, 0
    v_accvgpr_write_b32 a3, 0
    v_accvgpr_write_b32 a4, 0
    v_accvgpr_write_b32 a5, 0
    v_accvgpr_write_b32 a6, 0
    v_accvgpr_write_b32 a7, 0
    v_accvgpr_write_b32 a8, 0
    v_accvgpr_write_b32 a9, 0
    v_accvgpr_write_b32 a10, 0
    v_accvgpr_write_b32 a11, 0
    v_accvgpr_write_b32 a12, 0
    v_accvgpr_write_b32 a13, 0
    v_accvgpr_write_b32 a14, 0
    v_accvgpr_write_b32 a15, 0
    v_accvgpr_write_b32 a16, 0
    v_accvgpr_write_b32 a17, 0
    v_accvgpr_write_b32 a18, 0
    v_accvgpr_write_b32 a19, 0
    v_accvgpr_write_b32 a20, 0
    v_accvgpr_write_b32 a21, 0
    v_accvgpr_write_b32 a22, 0
    v_accvgpr_write_b32 a23, 0
    v_accvgpr_write_b32 a24, 0
    v_accvgpr_write_b32 a25, 0
    v_accvgpr_write_b32 a26, 0
    v_accvgpr_write_b32 a27, 0
    v_accvgpr_write_b32 a28, 0
    v_accvgpr_write_b32 a29, 0
    v_accvgpr_write_b32 a30, 0
    v_accvgpr_write_b32 a31, 0
    v_accvgpr_write_b32 a32, 0
    v_accvgpr_write_b32 a33, 0
    v_accvgpr_write_b32 a34, 0
    v_accvgpr_write_b32 a35, 0
    v_accvgpr_write_b32 a36, 0
    v_accvgpr_write_b32 a37, 0
    v_accvgpr_write_b32 a38, 0
    v_accvgpr_write_b32 a39, 0
    v_accvgpr_write_b32 a40, 0
    v_accvgpr_write_b32 a41, 0
    v_accvgpr_write_b32 a42, 0
    v_accvgpr_write_b32 a43, 0
    v_accvgpr_write_b32 a44, 0
    v_accvgpr_write_b32 a45, 0
    v_accvgpr_write_b32 a46, 0
    v_accvgpr_write_b32 a47, 0
    v_accvgpr_write_b32 a48, 0
    v_accvgpr_write_b32 a49, 0
    v_accvgpr_write_b32 a50, 0
    v_accvgpr_write_b32 a51, 0
    v_accvgpr_write_b32 a52, 0
    v_accvgpr_write_b32 a53, 0
    v_accvgpr_write_b32 a54, 0
    v_accvgpr_write_b32 a55, 0
    v_accvgpr_write_b32 a56, 0
    v_accvgpr_write_b32 a57, 0
    v_accvgpr_write_b32 a58, 0
    v_accvgpr_write_b32 a59, 0
    v_accvgpr_write_b32 a60, 0
    v_accvgpr_write_b32 a61, 0
    v_accvgpr_write_b32 a62, 0
    v_accvgpr_write_b32 a63, 0
    v_accvgpr_write_b32 a64, 0
    v_accvgpr_write_b32 a65, 0
    v_accvgpr_write_b32 a66, 0
    v_accvgpr_write_b32 a67, 0
    v_accvgpr_write_b32 a68, 0
    v_accvgpr_write_b32 a69, 0
    v_accvgpr_write_b32 a70, 0
    v_accvgpr_write_b32 a71, 0
    v_accvgpr_write_b32 a72, 0
    v_accvgpr_write_b32 a73, 0
    v_accvgpr_write_b32 a74, 0
    v_accvgpr_write_b32 a75, 0
    v_accvgpr_write_b32 a76, 0
    v_accvgpr_write_b32 a77, 0
    v_accvgpr_write_b32 a78, 0
    v_accvgpr_write_b32 a79, 0
    v_accvgpr_write_b32 a80, 0
    v_accvgpr_write_b32 a81, 0
    v_accvgpr_write_b32 a82, 0
    v_accvgpr_write_b32 a83, 0
    v_accvgpr_write_b32 a84, 0
    v_accvgpr_write_b32 a85, 0
    v_accvgpr_write_b32 a86, 0
    v_accvgpr_write_b32 a87, 0
    v_accvgpr_write_b32 a88, 0
    v_accvgpr_write_b32 a89, 0
    v_accvgpr_write_b32 a90, 0
    v_accvgpr_write_b32 a91, 0
    v_accvgpr_write_b32 a92, 0
    v_accvgpr_write_b32 a93, 0
    v_accvgpr_write_b32 a94, 0
    v_accvgpr_write_b32 a95, 0
    v_accvgpr_write_b32 a96, 0
    v_accvgpr_write_b32 a97, 0
    v_accvgpr_write_b32 a98, 0
    v_accvgpr_write_b32 a99, 0
    v_accvgpr_write_b32 a100, 0
    v_accvgpr_write_b32 a101, 0
    v_accvgpr_write_b32 a102, 0
    v_accvgpr_write_b32 a103, 0
    v_accvgpr_write_b32 a104, 0
    v_accvgpr_write_b32 a105, 0
    v_accvgpr_write_b32 a106, 0
    v_accvgpr_write_b32 a107, 0
    v_accvgpr_write_b32 a108, 0
    v_accvgpr_write_b32 a109, 0
    v_accvgpr_write_b32 a110, 0
    v_accvgpr_write_b32 a111, 0
    v_accvgpr_write_b32 a112, 0
    v_accvgpr_write_b32 a113, 0
    v_accvgpr_write_b32 a114, 0
    v_accvgpr_write_b32 a115, 0
    v_accvgpr_write_b32 a116, 0
    v_accvgpr_write_b32 a117, 0
    v_accvgpr_write_b32 a118, 0
    v_accvgpr_write_b32 a119, 0
    v_accvgpr_write_b32 a120, 0
    v_accvgpr_write_b32 a121, 0
    v_accvgpr_write_b32 a122, 0
    v_accvgpr_write_b32 a123, 0
    v_accvgpr_write_b32 a124, 0
    v_accvgpr_write_b32 a125, 0
    v_accvgpr_write_b32 a126, 0
    v_accvgpr_write_b32 a127, 0
    v_accvgpr_write_b32 a128, 0
    v_accvgpr_write_b32 a129, 0
    v_accvgpr_write_b32 a130, 0
    v_accvgpr_write_b32 a131, 0
    v_accvgpr_write_b32 a132, 0
    v_accvgpr_write_b32 a133, 0
    v_accvgpr_write_b32 a134, 0
    v_accvgpr_write_b32 a135, 0
    v_accvgpr_write_b32 a136, 0
    v_accvgpr_write_b32 a137, 0
    v_accvgpr_write_b32 a138, 0
    v_accvgpr_write_b32 a139, 0
    v_accvgpr_write_b32 a140, 0
    v_accvgpr_write_b32 a141, 0
    v_accvgpr_write_b32 a142, 0
    v_accvgpr_write_b32 a143, 0
    v_accvgpr_write_b32 a144, 0
    v_accvgpr_write_b32 a145, 0
    v_accvgpr_write_b32 a146, 0
    v_accvgpr_write_b32 a147, 0
    v_accvgpr_write_b32 a148, 0
    v_accvgpr_write_b32 a149, 0
    v_accvgpr_write_b32 a150, 0
    v_accvgpr_write_b32 a151, 0
    v_accvgpr_write_b32 a152, 0
    v_accvgpr_write_b32 a153, 0
    v_accvgpr_write_b32 a154, 0
    v_accvgpr_write_b32 a155, 0
    v_accvgpr_write_b32 a156, 0
    v_accvgpr_write_b32 a157, 0
    v_accvgpr_write_b32 a158, 0
    v_accvgpr_write_b32 a159, 0
    v_accvgpr_write_b32 a160, 0
    v_accvgpr_write_b32 a161, 0
    v_accvgpr_write_b32 a162, 0
    v_accvgpr_write_b32 a163, 0
    v_accvgpr_write_b32 a164, 0
    v_accvgpr_write_b32 a165, 0
    v_accvgpr_write_b32 a166, 0
    v_accvgpr_write_b32 a167, 0
    v_accvgpr_write_b32 a168, 0
    v_accvgpr_write_b32 a169, 0
    v_accvgpr_write_b32 a170, 0
    v_accvgpr_write_b32 a171, 0
    v_accvgpr_write_b32 a172, 0
    v_accvgpr_write_b32 a173, 0
    v_accvgpr_write_b32 a174, 0
    v_accvgpr_write_b32 a175, 0
    v_accvgpr_write_b32 a176, 0
    v_accvgpr_write_b32 a177, 0
    v_accvgpr_write_b32 a178, 0
    v_accvgpr_write_b32 a179, 0
    v_accvgpr_write_b32 a180, 0
    v_accvgpr_write_b32 a181, 0
    v_accvgpr_write_b32 a182, 0
    v_accvgpr_write_b32 a183, 0
    v_accvgpr_write_b32 a184, 0
    v_accvgpr_write_b32 a185, 0
    v_accvgpr_write_b32 a186, 0
    v_accvgpr_write_b32 a187, 0
    v_accvgpr_write_b32 a188, 0
    v_accvgpr_write_b32 a189, 0
    v_accvgpr_write_b32 a190, 0
    v_accvgpr_write_b32 a191, 0
    v_accvgpr_write_b32 a192, 0
    v_accvgpr_write_b32 a193, 0
    v_accvgpr_write_b32 a194, 0
    v_accvgpr_write_b32 a195, 0
    v_accvgpr_write_b32 a196, 0
    v_accvgpr_write_b32 a197, 0
    v_accvgpr_write_b32 a198, 0
    v_accvgpr_write_b32 a199, 0
    v_accvgpr_write_b32 a200, 0
    v_accvgpr_write_b32 a201, 0
    v_accvgpr_write_b32 a202, 0
    v_accvgpr_write_b32 a203, 0
    v_accvgpr_write_b32 a204, 0
    v_accvgpr_write_b32 a205, 0
    v_accvgpr_write_b32 a206, 0
    v_accvgpr_write_b32 a207, 0
    v_accvgpr_write_b32 a208, 0
    v_accvgpr_write_b32 a209, 0
    v_accvgpr_write_b32 a210, 0
    v_accvgpr_write_b32 a211, 0
    v_accvgpr_write_b32 a212, 0
    v_accvgpr_write_b32 a213, 0
    v_accvgpr_write_b32 a214, 0
    v_accvgpr_write_b32 a215, 0
    v_accvgpr_write_b32 a216, 0
    v_accvgpr_write_b32 a217, 0
    v_accvgpr_write_b32 a218, 0
    v_accvgpr_write_b32 a219, 0
    v_accvgpr_write_b32 a220, 0
    v_accvgpr_write_b32 a221, 0
    v_accvgpr_write_b32 a222, 0
    v_accvgpr_write_b32 a223, 0
    v_accvgpr_write_b32 a224, 0
    v_accvgpr_write_b32 a225, 0
    v_accvgpr_write_b32 a226, 0
    v_accvgpr_write_b32 a227, 0
    v_accvgpr_write_b32 a228, 0
    v_accvgpr_write_b32 a229, 0
    v_accvgpr_write_b32 a230, 0
    v_accvgpr_write_b32 a231, 0
    v_accvgpr_write_b32 a232, 0
    v_accvgpr_write_b32 a233, 0
    v_accvgpr_write_b32 a234, 0
    v_accvgpr_write_b32 a235, 0
    v_accvgpr_write_b32 a236, 0
    v_accvgpr_write_b32 a237, 0
    v_accvgpr_write_b32 a238, 0
    v_accvgpr_write_b32 a239, 0
    v_accvgpr_write_b32 a240, 0
    v_accvgpr_write_b32 a241, 0
    v_accvgpr_write_b32 a242, 0
    v_accvgpr_write_b32 a243, 0
    v_accvgpr_write_b32 a244, 0
    v_accvgpr_write_b32 a245, 0
    v_accvgpr_write_b32 a246, 0
    v_accvgpr_write_b32 a247, 0
    v_accvgpr_write_b32 a248, 0
    v_accvgpr_write_b32 a249, 0
    v_accvgpr_write_b32 a250, 0
    v_accvgpr_write_b32 a251, 0
    v_accvgpr_write_b32 a252, 0
    v_accvgpr_write_b32 a253, 0
    v_accvgpr_write_b32 a254, 0
    v_accvgpr_write_b32 a255, 0
    v_mov_b32 v224, 0
    v_mov_b32 v225, 0
    v_mov_b32 v226, 0
    v_mov_b32 v227, 0
    v_mov_b32 v228, 0
    v_mov_b32 v229, 0
    v_mov_b32 v230, 0
    v_mov_b32 v231, 0
    v_mov_b32 v232, 0
    v_mov_b32 v233, 0
    v_mov_b32 v234, 0
    v_mov_b32 v235, 0
    v_mov_b32 v236, 0
    v_mov_b32 v237, 0
    v_mov_b32 v238, 0
    v_mov_b32 v239, 0
    v_mov_b32 v240, 0
    v_mov_b32 v241, 0
    v_mov_b32 v242, 0
    v_mov_b32 v243, 0
    v_mov_b32 v244, 0
    v_mov_b32 v245, 0
    v_mov_b32 v246, 0
    v_mov_b32 v247, 0
    v_mov_b32 v248, 0
    v_mov_b32 v249, 0
    v_mov_b32 v250, 0
    v_mov_b32 v251, 0
    v_mov_b32 v252, 0
    v_mov_b32 v253, 0
    v_mov_b32 v254, 0
    v_mov_b32 v255, 0
    s_mov_b32 s74, 0
kloop_700001:
    s_waitcnt vmcnt(0) lgkmcnt(0)
    s_barrier
    v_add_u32 v33, s73, v27
    v_add_u32 v34, s73, v28
    v_add_u32 v35, s73, v31
    ds_read_b128 v[40:43], v33 offset:0
    ds_read_b128 v[44:47], v33 offset:2048
    ds_read_b128 v[48:51], v33 offset:4096
    ds_read_b128 v[52:55], v33 offset:6144
    ds_read_b64_tr_b16 v[56:57], v35 offset:0
    ds_read_b64_tr_b16 v[58:59], v35 offset:4608
    ds_read_b64_tr_b16 v[60:61], v35 offset:32
    ds_read_b64_tr_b16 v[62:63], v35 offset:4640
    ds_read_b64_tr_b16 v[64:65], v35 offset:64
    ds_read_b64_tr_b16 v[66:67], v35 offset:4672
    s_waitcnt lgkmcnt(4)
    v_mfma_f32_16x16x32_bf16 a[0:3], v[56:59], v[40:43], a[0:3]
    v_mfma_f32_16x16x32_bf16 a[4:7], v[56:59], v[44:47], a[4:7]
    v_mfma_f32_16x16x32_bf16 a[8:11], v[56:59], v[48:51], a[8:11]
    v_mfma_f32_16x16x32_bf16 a[12:15], v[56:59], v[52:55], a[12:15]
    ds_read_b64_tr_b16 v[68:69], v35 offset:96
    ds_read_b64_tr_b16 v[70:71], v35 offset:4704
    s_min_u32 s72, s70, 8
    s_lshl_b32 s30, s72, 6
    s_add_u32 s30, s30, s22
    s_mul_i32 s31, s30, 9216
    s_lshl_b32 s30, s30, 1
    s_mul_i32 s32, s23, 8192
    s_add_u32 s32, s32, s71
    s_add_u32 m0, s32, 0
    s_nop 0
    buffer_load_dwordx4 v8, s[40:43], s30 offen lds
    s_waitcnt lgkmcnt(4)
    v_mfma_f32_16x16x32_bf16 a[16:19], v[60:63], v[40:43], a[16:19]
    v_mfma_f32_16x16x32_bf16 a[20:23], v[60:63], v[44:47], a[20:23]
    v_mfma_f32_16x16x32_bf16 a[24:27], v[60:63], v[48:51], a[24:27]
    v_mfma_f32_16x16x32_bf16 a[28:31], v[60:63], v[52:55], a[28:31]
    ds_read_b64_tr_b16 v[56:57], v35 offset:128
    ds_read_b64_tr_b16 v[58:59], v35 offset:4736
    s_add_u32 m0, s32, 1024
    s_nop 0
    buffer_load_dwordx4 v9, s[40:43], s30 offen lds
    s_waitcnt lgkmcnt(4)
    v_mfma_f32_16x16x32_bf16 a[32:35], v[64:67], v[40:43], a[32:35]
    v_mfma_f32_16x16x32_bf16 a[36:39], v[64:67], v[44:47], a[36:39]
    v_mfma_f32_16x16x32_bf16 a[40:43], v[64:67], v[48:51], a[40:43]
    v_mfma_f32_16x16x32_bf16 a[44:47], v[64:67], v[52:55], a[44:47]
    ds_read_b64_tr_b16 v[60:61], v35 offset:160
    ds_read_b64_tr_b16 v[62:63], v35 offset:4768
    s_add_u32 m0, s32, 2048
    s_nop 0
    buffer_load_dwordx4 v10, s[40:43], s30 offen lds
    s_waitcnt lgkmcnt(4)
    v_mfma_f32_16x16x32_bf16 a[48:51], v[68:71], v[40:43], a[48:51]
    v_mfma_f32_16x16x32_bf16 a[52:55], v[68:71], v[44:47], a[52:55]
    v_mfma_f32_16x16x32_bf16 a[56:59], v[68:71], v[48:51], a[56:59]
    v_mfma_f32_16x16x32_bf16 a[60:63], v[68:71], v[52:55], a[60:63]
    ds_read_b64_tr_b16 v[64:65], v35 offset:192
    ds_read_b64_tr_b16 v[66:67], v35 offset:4800
    s_add_u32 m0, s32, 3072
    s_nop 0
    buffer_load_dwordx4 v11, s[40:43], s30 offen lds
    s_waitcnt lgkmcnt(4)
    v_mfma_f32_16x16x32_bf16 a[64:67], v[56:59], v[40:43], a[64:67]
    v_mfma_f32_16x16x32_bf16 a[68:71], v[56:59], v[44:47], a[68:71]
    v_mfma_f32_16x16x32_bf16 a[72:75], v[56:59], v[48:51], a[72:75]
    v_mfma_f32_16x16x32_bf16 a[76:79], v[56:59], v[52:55], a[76:79]
    ds_read_b64_tr_b16 v[68:69], v35 offset:224
    ds_read_b64_tr_b16 v[70:71], v35 offset:4832
    s_add_u32 m0, s32, 4096
    s_nop 0
    buffer_load_dwordx4 v12, s[40:43], s30 offen lds
    s_waitcnt lgkmcnt(4)
    v_mfma_f32_16x16x32_bf16 a[80:83], v[60:63], v[40:43], a[80:83]
    v_mfma_f32_16x16x32_bf16 a[84:87], v[60:63], v[44:47], a[84:87]
    v_mfma_f32_16x16x32_bf16 a[88:91], v[60:63], v[48:51], a[88:91]
    v_mfma_f32_16x16x32_bf16 a[92:95], v[60:63], v[52:55], a[92:95]
    ds_read_b64_tr_b16 v[56:57], v35 offset:256
    ds_read_b64_tr_b16 v[58:59], v35 offset:4864
    s_add_u32 m0, s32, 5120
    s_nop 0
    buffer_load_dwordx4 v13, s[40:43], s30 offen lds
    s_waitcnt lgkmcnt(4)
    v_mfma_f32_16x16x32_bf16 a[96:99], v[64:67], v[40:43], a[96:99]
    v_mfma_f32_16x16x32_bf16 a[100:103], v[64:67], v[44:47], a[100:103]
    v_mfma_f32_16x16x32_bf16 a[104:107], v[64:67], v[48:51], a[104:107]
    v_mfma_f32_16x16x32_bf16 a[108:111], v[64:67], v[52:55], a[108:111]
    ds_read_b64_tr_b16 v[60:61], v35 offset:18432
    ds_read_b64_tr_b16 v[62:63], v35 offset:23040
    s_add_u32 m0, s32, 6144
    s_nop 0
    buffer_load_dwordx4 v14, s[40:43], s30 offen lds
    s_waitcnt lgkmcnt(4)
    v_mfma_f32_16x16x32_bf16 a[112:115], v[68:71], v[40:43], a[112:115]
    v_mfma_f32_16x16x32_bf16 a[116:119], v[68:71], v[44:47], a[116:119]
    v_mfma_f32_16x16x32_bf16 a[120:123], v[68:71], v[48:51], a[120:123]
    v_mfma_f32_16x16x32_bf16 a[124:127], v[68:71], v[52:55], a[124:127]
    ds_read_b64_tr_b16 v[64:65], v35 offset:18464
    ds_read_b64_tr_b16 v[66:67], v35 offset:23072
    s_add_u32 m0, s32, 7168
    s_nop 0
    buffer_load_dwordx4 v15, s[40:43], s30 offen lds
    s_waitcnt lgkmcnt(4)
    v_mfma_f32_16x16x32_bf16 a[128:131], v[56:59], v[40:43], a[128:131]
    v_mfma_f32_16x16x32_bf16 a[132:135], v[56:59], v[44:47], a[132:135]
    v_mfma_f32_16x16x32_bf16 a[136:139], v[56:59], v[48:51], a[136:139]
    v_mfma_f32_16x16x32_bf16 a[140:143], v[56:59], v[52:55], a[140:143]
    ds_read_b64_tr_b16 v[68:69], v35 offset:18496
    ds_read_b64_tr_b16 v[70:71], v35 offset:23104
    s_add_u32 s33, s23, 0
    s_min_u32 s33, s33, 17
    s_lshl_b32 s33, s33, 10
    s_add_u32 s33, s33, s71
    s_add_u32 m0, s33, 32768
    s_nop 0
    buffer_load_dwordx4 v17, s[44:47], s31 offen lds
    s_waitcnt lgkmcnt(4)
    v_mfma_f32_16x16x32_bf16 a[144:147], v[60:63], v[40:43], a[144:147]
    v_mfma_f32_16x16x32_bf16 a[148:151], v[60:63], v[44:47], a[148:151]
    v_mfma_f32_16x16x32_bf16 a[152:155], v[60:63], v[48:51], a[152:155]
    v_mfma_f32_16x16x32_bf16 a[156:159], v[60:63], v[52:55], a[156:159]
    ds_read_b64_tr_b16 v[56:57], v35 offset:18528
    ds_read_b64_tr_b16 v[58:59], v35 offset:23136
    s_add_u32 s33, s23, 4
    s_min_u32 s33, s33, 17
    s_lshl_b32 s33, s33, 10
    s_add_u32 s33, s33, s71
    s_add_u32 m0, s33, 32768
    s_nop 0
    buffer_load_dwordx4 v18, s[44:47], s31 offen lds
    s_waitcnt lgkmcnt(4)
    v_mfma_f32_16x16x32_bf16 a[160:163], v[64:67], v[40:43], a[160:163]
    v_mfma_f32_16x16x32_bf16 a[164:167], v[64:67], v[44:47], a[164:167]
    v_mfma_f32_16x16x32_bf16 a[168:171], v[64:67], v[48:51], a[168:171]
    v_mfma_f32_16x16x32_bf16 a[172:175], v[64:67], v[52:55], a[172:175]
    ds_read_b64_tr_b16 v[60:61], v35 offset:18560
    ds_read_b64_tr_b16 v[62:63], v35 offset:23168
    s_add_u32 s33, s23, 8
    s_min_u32 s33, s33, 17
    s_lshl_b32 s33, s33, 10
    s_add_u32 s33, s33, s71
    s_add_u32 m0, s33, 32768
    s_nop 0
    buffer_load_dwordx4 v19, s[44:47], s31 offen lds
    s_waitcnt lgkmcnt(4)
    v_mfma_f32_16x16x32_bf16 a[176:179], v[68:71], v[40:43], a[176:179]
    v_mfma_f32_16x16x32_bf16 a[180:183], v[68:71], v[44:47], a[180:183]
    v_mfma_f32_16x16x32_bf16 a[184:187], v[68:71], v[48:51], a[184:187]
    v_mfma_f32_16x16x32_bf16 a[188:191], v[68:71], v[52:55], a[188:191]
    ds_read_b64_tr_b16 v[64:65], v35 offset:18592
    ds_read_b64_tr_b16 v[66:67], v35 offset:23200
    s_add_u32 s33, s23, 12
    s_min_u32 s33, s33, 17
    s_lshl_b32 s33, s33, 10
    s_add_u32 s33, s33, s71
    s_add_u32 m0, s33, 32768
    s_nop 0
    buffer_load_dwordx4 v20, s[44:47], s31 offen lds
    s_waitcnt lgkmcnt(4)
    v_mfma_f32_16x16x32_bf16 a[192:195], v[56:59], v[40:43], a[192:195]
    v_mfma_f32_16x16x32_bf16 a[196:199], v[56:59], v[44:47], a[196:199]
    v_mfma_f32_16x16x32_bf16 a[200:203], v[56:59], v[48:51], a[200:203]
    v_mfma_f32_16x16x32_bf16 a[204:207], v[56:59], v[52:55], a[204:207]
    ds_read_b64_tr_b16 v[68:69], v35 offset:18624
    ds_read_b64_tr_b16 v[70:71], v35 offset:23232
    s_add_u32 s33, s23, 16
    s_min_u32 s33, s33, 17
    s_lshl_b32 s33, s33, 10
    s_add_u32 s33, s33, s71
    s_add_u32 m0, s33, 32768
    s_nop 0
    buffer_load_dwordx4 v21, s[44:47], s31 offen lds
    s_waitcnt lgkmcnt(4)
    v_mfma_f32_16x16x32_bf16 a[208:211], v[60:63], v[40:43], a[208:211]
    v_mfma_f32_16x16x32_bf16 a[212:215], v[60:63], v[44:47], a[212:215]
    v_mfma_f32_16x16x32_bf16 a[216:219], v[60:63], v[48:51], a[216:219]
    v_mfma_f32_16x16x32_bf16 a[220:223], v[60:63], v[52:55], a[220:223]
    ds_read_b64_tr_b16 v[56:57], v35 offset:18656
    ds_read_b64_tr_b16 v[58:59], v35 offset:23264
    s_add_u32 s33, s23, 0
    s_min_u32 s33, s33, 17
    s_lshl_b32 s33, s33, 10
    s_add_u32 s33, s33, s71
    s_add_u32 m0, s33, 51200
    s_nop 0
    buffer_load_dwordx4 v17, s[48:51], s31 offen lds
    s_waitcnt lgkmcnt(4)
    v_mfma_f32_16x16x32_bf16 a[224:227], v[64:67], v[40:43], a[224:227]
    v_mfma_f32_16x16x32_bf16 a[228:231], v[64:67], v[44:47], a[228:231]
    v_mfma_f32_16x16x32_bf16 a[232:235], v[64:67], v[48:51], a[232:235]
    v_mfma_f32_16x16x32_bf16 a[236:239], v[64:67], v[52:55], a[236:239]
    ds_read_b64_tr_b16 v[60:61], v35 offset:18688
    ds_read_b64_tr_b16 v[62:63], v35 offset:23296
    s_add_u32 s33, s23, 4
    s_min_u32 s33, s33, 17
    s_lshl_b32 s33, s33, 10
    s_add_u32 s33, s33, s71
    s_add_u32 m0, s33, 51200
    s_nop 0
    buffer_load_dwordx4 v18, s[48:51], s31 offen lds
    s_waitcnt lgkmcnt(4)
    v_mfma_f32_16x16x32_bf16 a[240:243], v[68:71], v[40:43], a[240:243]
    v_mfma_f32_16x16x32_bf16 a[244:247], v[68:71], v[44:47], a[244:247]
    v_mfma_f32_16x16x32_bf16 a[248:251], v[68:71], v[48:51], a[248:251]
    v_mfma_f32_16x16x32_bf16 a[252:255], v[68:71], v[52:55], a[252:255]
    s_add_u32 s33, s23, 8
    s_min_u32 s33, s33, 17
    s_lshl_b32 s33, s33, 10
    s_add_u32 s33, s33, s71
    s_add_u32 m0, s33, 51200
    s_nop 0
    buffer_load_dwordx4 v19, s[48:51], s31 offen lds
    s_waitcnt lgkmcnt(2)
    v_mfma_f32_16x16x32_bf16 v[224:227], v[56:59], v[40:43], v[224:227]
    v_mfma_f32_16x16x32_bf16 v[228:231], v[56:59], v[44:47], v[228:231]
    v_mfma_f32_16x16x32_bf16 v[232:235], v[56:59], v[48:51], v[232:235]
    v_mfma_f32_16x16x32_bf16 v[236:239], v[56:59], v[52:55], v[236:239]
    s_add_u32 s33, s23, 12
    s_min_u32 s33, s33, 17
    s_lshl_b32 s33, s33, 10
    s_add_u32 s33, s33, s71
    s_add_u32 m0, s33, 51200
    s_nop 0
    buffer_load_dwordx4 v20, s[48:51], s31 offen lds
    s_waitcnt lgkmcnt(0)
    v_mfma_f32_16x16x32_bf16 v[240:243], v[60:63], v[40:43], v[240:243]
    v_mfma_f32_16x16x32_bf16 v[244:247], v[60:63], v[44:47], v[244:247]
    v_mfma_f32_16x16x32_bf16 v[248:251], v[60:63], v[48:51], v[248:251]
    v_mfma_f32_16x16x32_bf16 v[252:255], v[60:63], v[52:55], v[252:255]
    s_add_u32 s33, s23, 16
    s_min_u32 s33, s33, 17
    s_lshl_b32 s33, s33, 10
    s_add_u32 s33, s33, s71
    s_add_u32 m0, s33, 51200
    s_nop 0
    buffer_load_dwordx4 v21, s[48:51], s31 offen lds
    ds_read_b128 v[40:43], v34 offset:0
    ds_read_b128 v[44:47], v34 offset:2048
    ds_read_b128 v[48:51], v34 offset:4096
    ds_read_b128 v[52:55], v34 offset:6144
    ds_read_b64_tr_b16 v[56:57], v35 offset:9216
    ds_read_b64_tr_b16 v[58:59], v35 offset:13824
    ds_read_b64_tr_b16 v[60:61], v35 offset:9248
    ds_read_b64_tr_b16 v[62:63], v35 offset:13856
    ds_read_b64_tr_b16 v[64:65], v35 offset:9280
    ds_read_b64_tr_b16 v[66:67], v35 offset:13888
    s_waitcnt lgkmcnt(4)
    v_mfma_f32_16x16x32_bf16 a[0:3], v[56:59], v[40:43], a[0:3]
    v_mfma_f32_16x16x32_bf16 a[4:7], v[56:59], v[44:47], a[4:7]
    v_mfma_f32_16x16x32_bf16 a[8:11], v[56:59], v[48:51], a[8:11]
    v_mfma_f32_16x16x32_bf16 a[12:15], v[56:59], v[52:55], a[12:15]
    ds_read_b64_tr_b16 v[68:69], v35 offset:9312
    ds_read_b64_tr_b16 v[70:71], v35 offset:13920
    s_waitcnt lgkmcnt(4)
    v_mfma_f32_16x16x32_bf16 a[16:19], v[60:63], v[40:43], a[16:19]
    v_mfma_f32_16x16x32_bf16 a[20:23], v[60:63], v[44:47], a[20:23]
    v_mfma_f32_16x16x32_bf16 a[24:27], v[60:63], v[48:51], a[24:27]
    v_mfma_f32_16x16x32_bf16 a[28:31], v[60:63], v[52:55], a[28:31]
    ds_read_b64_tr_b16 v[56:57], v35 offset:9344
    ds_read_b64_tr_b16 v[58:59], v35 offset:13952
    s_waitcnt lgkmcnt(4)
    v_mfma_f32_16x16x32_bf16 a[32:35], v[64:67], v[40:43], a[32:35]
    v_mfma_f32_16x16x32_bf16 a[36:39], v[64:67], v[44:47], a[36:39]
    v_mfma_f32_16x16x32_bf16 a[40:43], v[64:67], v[48:51], a[40:43]
    v_mfma_f32_16x16x32_bf16 a[44:47], v[64:67], v[52:55], a[44:47]
    ds_read_b64_tr_b16 v[60:61], v35 offset:9376
    ds_read_b64_tr_b16 v[62:63], v35 offset:13984
    s_waitcnt lgkmcnt(4)
    v_mfma_f32_16x16x32_bf16 a[48:51], v[68:71], v[40:43], a[48:51]
    v_mfma_f32_16x16x32_bf16 a[52:55], v[68:71], v[44:47], a[52:55]
    v_mfma_f32_16x16x32_bf16 a[56:59], v[68:71], v[48:51], a[56:59]
    v_mfma_f32_16x16x32_bf16 a[60:63], v[68:71], v[52:55], a[60:63]
    ds_read_b64_tr_b16 v[64:65], v35 offset:9408
    ds_read_b64_tr_b16 v[66:67], v35 offset:14016
    s_waitcnt lgkmcnt(4)
    v_mfma_f32_16x16x32_bf16 a[64:67], v[56:59], v[40:43], a[64:67]
    v_mfma_f32_16x16x32_bf16 a[68:71], v[56:59], v[44:47], a[68:71]
    v_mfma_f32_16x16x32_bf16 a[72:75], v[56:59], v[48:51], a[72:75]
    v_mfma_f32_16x16x32_bf16 a[76:79], v[56:59], v[52:55], a[76:79]
    ds_read_b64_tr_b16 v[68:69], v35 offset:9440
    ds_read_b64_tr_b16 v[70:71], v35 offset:14048
    s_waitcnt lgkmcnt(4)
    v_mfma_f32_16x16x32_bf16 a[80:83], v[60:63], v[40:43], a[80:83]
    v_mfma_f32_16x16x32_bf16 a[84:87], v[60:63], v[44:47], a[84:87]
    v_mfma_f32_16x16x32_bf16 a[88:91], v[60:63], v[48:51], a[88:91]
    v_mfma_f32_16x16x32_bf16 a[92:95], v[60:63], v[52:55], a[92:95]
    ds_read_b64_tr_b16 v[56:57], v35 offset:9472
    ds_read_b64_tr_b16 v[58:59], v35 offset:14080
    s_waitcnt lgkmcnt(4)
    v_mfma_f32_16x16x32_bf16 a[96:99], v[64:67], v[40:43], a[96:99]
    v_mfma_f32_16x16x32_bf16 a[100:103], v[64:67], v[44:47], a[100:103]
    v_mfma_f32_16x16x32_bf16 a[104:107], v[64:67], v[48:51], a[104:107]
    v_mfma_f32_16x16x32_bf16 a[108:111], v[64:67], v[52:55], a[108:111]
    ds_read_b64_tr_b16 v[60:61], v35 offset:27648
    ds_read_b64_tr_b16 v[62:63], v35 offset:32256
    s_waitcnt lgkmcnt(4)
    v_mfma_f32_16x16x32_bf16 a[112:115], v[68:71], v[40:43], a[112:115]
    v_mfma_f32_16x16x32_bf16 a[116:119], v[68:71], v[44:47], a[116:119]
    v_mfma_f32_16x16x32_bf16 a[120:123], v[68:71], v[48:51], a[120:123]
    v_mfma_f32_16x16x32_bf16 a[124:127], v[68:71], v[52:55], a[124:127]
    ds_read_b64_tr_b16 v[64:65], v35 offset:27680
    ds_read_b64_tr_b16 v[66:67], v35 offset:32288
    s_waitcnt lgkmcnt(4)
    v_mfma_f32_16x16x32_bf16 a[128:131], v[56:59], v[40:43], a[128:131]
    v_mfma_f32_16x16x32_bf16 a[132:135], v[56:59], v[44:47], a[132:135]
    v_mfma_f32_16x16x32_bf16 a[136:139], v[56:59], v[48:51], a[136:139]
    v_mfma_f32_16x16x32_bf16 a[140:143], v[56:59], v[52:55], a[140:143]
    ds_read_b64_tr_b16 v[68:69], v35 offset:27712
    ds_read_b64_tr_b16 v[70:71], v35 offset:32320
    s_waitcnt lgkmcnt(4)
    v_mfma_f32_16x16x32_bf16 a[144:147], v[60:63], v[40:43], a[144:147]
    v_mfma_f32_16x16x32_bf16 a[148:151], v[60:63], v[44:47], a[148:151]
    v_mfma_f32_16x16x32_bf16 a[152:155], v[60:63], v[48:51], a[152:155]
    v_mfma_f32_16x16x32_bf16 a[156:159], v[60:63], v[52:55], a[156:159]
    ds_read_b64_tr_b16 v[56:57], v35 offset:27744
    ds_read_b64_tr_b16 v[58:59], v35 offset:32352
    s_waitcnt lgkmcnt(4)
    v_mfma_f32_16x16x32_bf16 a[160:163], v[64:67], v[40:43], a[160:163]
    v_mfma_f32_16x16x32_bf16 a[164:167], v[64:67], v[44:47], a[164:167]
    v_mfma_f32_16x16x32_bf16 a[168:171], v[64:67], v[48:51], a[168:171]
    v_mfma_f32_16x16x32_bf16 a[172:175], v[64:67], v[52:55], a[172:175]
    ds_read_b64_tr_b16 v[60:61], v35 offset:27776
    ds_read_b64_tr_b16 v[62:63], v35 offset:32384
    s_waitcnt lgkmcnt(4)
    v_mfma_f32_16x16x32_bf16 a[176:179], v[68:71], v[40:43], a[176:179]
    v_mfma_f32_16x16x32_bf16 a[180:183], v[68:71], v[44:47], a[180:183]
    v_mfma_f32_16x16x32_bf16 a[184:187], v[68:71], v[48:51], a[184:187]
    v_mfma_f32_16x16x32_bf16 a[188:191], v[68:71], v[52:55], a[188:191]
    ds_read_b64_tr_b16 v[64:65], v35 offset:27808
    ds_read_b64_tr_b16 v[66:67], v35 offset:32416
    s_waitcnt lgkmcnt(4)
    v_mfma_f32_16x16x32_bf16 a[192:195], v[56:59], v[40:43], a[192:195]
    v_mfma_f32_16x16x32_bf16 a[196:199], v[56:59], v[44:47], a[196:199]
    v_mfma_f32_16x16x32_bf16 a[200:203], v[56:59], v[48:51], a[200:203]
    v_mfma_f32_16x16x32_bf16 a[204:207], v[56:59], v[52:55], a[204:207]
    ds_read_b64_tr_b16 v[68:69], v35 offset:27840
    ds_read_b64_tr_b16 v[70:71], v35 offset:32448
    s_waitcnt lgkmcnt(4)
    v_mfma_f32_16x16x32_bf16 a[208:211], v[60:63], v[40:43], a[208:211]
    v_mfma_f32_16x16x32_bf16 a[212:215], v[60:63], v[44:47], a[212:215]
    v_mfma_f32_16x16x32_bf16 a[216:219], v[60:63], v[48:51], a[216:219]
    v_mfma_f32_16x16x32_bf16 a[220:223], v[60:63], v[52:55], a[220:223]
    ds_read_b64_tr_b16 v[56:57], v35 offset:27872
    ds_read_b64_tr_b16 v[58:59], v35 offset:32480
    s_waitcnt lgkmcnt(4)
    v_mfma_f32_16x16x32_bf16 a[224:227], v[64:67], v[40:43], a[224:227]
    v_mfma_f32_16x16x32_bf16 a[228:231], v[64:67], v[44:47], a[228:231]
    v_mfma_f32_16x16x32_bf16 a[232:235], v[64:67], v[48:51], a[232:235]
    v_mfma_f32_16x16x32_bf16 a[236:239], v[64:67], v[52:55], a[236:239]
    ds_read_b64_tr_b16 v[60:61], v35 offset:27904
    ds_read_b64_tr_b16 v[62:63], v35 offset:32512
    s_waitcnt lgkmcnt(4)
    v_mfma_f32_16x16x32_bf16 a[240:243], v[68:71], v[40:43], a[240:243]
    v_mfma_f32_16x16x32_bf16 a[244:247], v[68:71], v[44:47], a[244:247]
    v_mfma_f32_16x16x32_bf16 a[248:251], v[68:71], v[48:51], a[248:251]
    v_mfma_f32_16x16x32_bf16 a[252:255], v[68:71], v[52:55], a[252:255]
    s_waitcnt lgkmcnt(2)
    v_mfma_f32_16x16x32_bf16 v[224:227], v[56:59], v[40:43], v[224:227]
    v_mfma_f32_16x16x32_bf16 v[228:231], v[56:59], v[44:47], v[228:231]
    v_mfma_f32_16x16x32_bf16 v[232:235], v[56:59], v[48:51], v[232:235]
    v_mfma_f32_16x16x32_bf16 v[236:239], v[56:59], v[52:55], v[236:239]
    s_waitcnt lgkmcnt(0)
    v_mfma_f32_16x16x32_bf16 v[240:243], v[60:63], v[40:43], v[240:243]
    v_mfma_f32_16x16x32_bf16 v[244:247], v[60:63], v[44:47], v[244:247]
    v_mfma_f32_16x16x32_bf16 v[248:251], v[60:63], v[48:51], v[248:251]
    v_mfma_f32_16x16x32_bf16 v[252:255], v[60:63], v[52:55], v[252:255]
    s_add_u32 s70, s70, 1
    s_add_u32 s71, s71, 69632
    s_cmp_ge_u32 s71, 139264
    s_cselect_b32 s71, 0, s71
    s_add_u32 s73, s73, 69632
    s_cmp_ge_u32 s73, 139264
    s_cselect_b32 s73, 0, s73
    s_add_u32 s74, s74, 1
    s_cmp_lt_u32 s74, 9
    s_cbranch_scc1 kloop_700001
    s_waitcnt vmcnt(0)
    s_nop 7
    s_nop 7
    s_barrier
    v_and_b32 v5, 15, v1
    s_lshl_b32 s26, s25, 6
    v_add_u32 v5, s26, v5
    v_mul_u32_u24 v9, 304, v5
    v_lshrrev_b32 v6, 4, v1
    v_lshlrev_b32 v6, 3, v6
    v_add_u32 v9, v9, v6
    v_accvgpr_read_b32 v40, a0
    v_accvgpr_read_b32 v44, a144
    v_accvgpr_read_b32 v41, a1
    v_accvgpr_read_b32 v45, a145
    v_accvgpr_read_b32 v42, a2
    v_accvgpr_read_b32 v46, a146
    v_accvgpr_read_b32 v43, a3
    v_accvgpr_read_b32 v47, a147
    v_mul_f32 v40, v40, v44
    v_mul_f32 v41, v41, v45
    v_mul_f32 v42, v42, v46
    v_mul_f32 v43, v43, v47
    v_cvt_pk_bf16_f32 v48, v40, v41
    v_cvt_pk_bf16_f32 v49, v42, v43
    ds_write_b64 v9, v[48:49] offset:0
    v_accvgpr_read_b32 v40, a16
    v_accvgpr_read_b32 v44, a160
    v_accvgpr_read_b32 v41, a17
    v_accvgpr_read_b32 v45, a161
    v_accvgpr_read_b32 v42, a18
    v_accvgpr_read_b32 v46, a162
    v_accvgpr_read_b32 v43, a19
    v_accvgpr_read_b32 v47, a163
    v_mul_f32 v40, v40, v44
    v_mul_f32 v41, v41, v45
    v_mul_f32 v42, v42, v46
    v_mul_f32 v43, v43, v47
    v_cvt_pk_bf16_f32 v50, v40, v41
    v_cvt_pk_bf16_f32 v51, v42, v43
    ds_write_b64 v9, v[50:51] offset:32
    v_accvgpr_read_b32 v40, a32
    v_accvgpr_read_b32 v44, a176
    v_accvgpr_read_b32 v41, a33
    v_accvgpr_read_b32 v45, a177
    v_accvgpr_read_b32 v42, a34
    v_accvgpr_read_b32 v46, a178
    v_accvgpr_read_b32 v43, a35
    v_accvgpr_read_b32 v47, a179
    v_mul_f32 v40, v40, v44
    v_mul_f32 v41, v41, v45
    v_mul_f32 v42, v42, v46
    v_mul_f32 v43, v43, v47
    v_cvt_pk_bf16_f32 v52, v40, v41
    v_cvt_pk_bf16_f32 v53, v42, v43
    ds_write_b64 v9, v[52:53] offset:64
    v_accvgpr_read_b32 v40, a48
    v_accvgpr_read_b32 v44, a192
    v_accvgpr_read_b32 v41, a49
    v_accvgpr_read_b32 v45, a193
    v_accvgpr_read_b32 v42, a50
    v_accvgpr_read_b32 v46, a194
    v_accvgpr_read_b32 v43, a51
    v_accvgpr_read_b32 v47, a195
    v_mul_f32 v40, v40, v44
    v_mul_f32 v41, v41, v45
    v_mul_f32 v42, v42, v46
    v_mul_f32 v43, v43, v47
    v_cvt_pk_bf16_f32 v54, v40, v41
    v_cvt_pk_bf16_f32 v55, v42, v43
    ds_write_b64 v9, v[54:55] offset:96
    v_accvgpr_read_b32 v40, a64
    v_accvgpr_read_b32 v44, a208
    v_accvgpr_read_b32 v41, a65
    v_accvgpr_read_b32 v45, a209
    v_accvgpr_read_b32 v42, a66
    v_accvgpr_read_b32 v46, a210
    v_accvgpr_read_b32 v43, a67
    v_accvgpr_read_b32 v47, a211
    v_mul_f32 v40, v40, v44
    v_mul_f32 v41, v41, v45
    v_mul_f32 v42, v42, v46
    v_mul_f32 v43, v43, v47
    v_cvt_pk_bf16_f32 v48, v40, v41
    v_cvt_pk_bf16_f32 v49, v42, v43
    ds_write_b64 v9, v[48:49] offset:128
    v_accvgpr_read_b32 v40, a80
    v_accvgpr_read_b32 v44, a224
    v_accvgpr_read_b32 v41, a81
    v_accvgpr_read_b32 v45, a225
    v_accvgpr_read_b32 v42, a82
    v_accvgpr_read_b32 v46, a226
    v_accvgpr_read_b32 v43, a83
    v_accvgpr_read_b32 v47, a227
    v_mul_f32 v40, v40, v44
    v_mul_f32 v41, v41, v45
    v_mul_f32 v42, v42, v46
    v_mul_f32 v43, v43, v47
    v_cvt_pk_bf16_f32 v50, v40, v41
    v_cvt_pk_bf16_f32 v51, v42, v43
    ds_write_b64 v9, v[50:51] offset:160
    v_accvgpr_read_b32 v40, a96
    v_accvgpr_read_b32 v44, a240
    v_accvgpr_read_b32 v41, a97
    v_accvgpr_read_b32 v45, a241
    v_accvgpr_read_b32 v42, a98
    v_accvgpr_read_b32 v46, a242
    v_accvgpr_read_b32 v43, a99
    v_accvgpr_read_b32 v47, a243
    v_mul_f32 v40, v40, v44
    v_mul_f32 v41, v41, v45
    v_mul_f32 v42, v42, v46
    v_mul_f32 v43, v43, v47
    v_cvt_pk_bf16_f32 v52, v40, v41
    v_cvt_pk_bf16_f32 v53, v42, v43
    ds_write_b64 v9, v[52:53] offset:192
    v_accvgpr_read_b32 v40, a112
    v_mov_b32 v44, v224
    v_accvgpr_read_b32 v41, a113
    v_mov_b32 v45, v225
    v_accvgpr_read_b32 v42, a114
    v_mov_b32 v46, v226
    v_accvgpr_read_b32 v43, a115
    v_mov_b32 v47, v227
    v_mul_f32 v40, v40, v44
    v_mul_f32 v41, v41, v45
    v_mul_f32 v42, v42, v46
    v_mul_f32 v43, v43, v47
    v_cvt_pk_bf16_f32 v54, v40, v41
    v_cvt_pk_bf16_f32 v55, v42, v43
    ds_write_b64 v9, v[54:55] offset:224
    v_accvgpr_read_b32 v40, a128
    v_mov_b32 v44, v240
    v_accvgpr_read_b32 v41, a129
    v_mov_b32 v45, v241
    v_accvgpr_read_b32 v42, a130
    v_mov_b32 v46, v242
    v_accvgpr_read_b32 v43, a131
    v_mov_b32 v47, v243
    v_mul_f32 v40, v40, v44
    v_mul_f32 v41, v41, v45
    v_mul_f32 v42, v42, v46
    v_mul_f32 v43, v43, v47
    v_cvt_pk_bf16_f32 v48, v40, v41
    v_cvt_pk_bf16_f32 v49, v42, v43
    ds_write_b64 v9, v[48:49] offset:256
    v_accvgpr_read_b32 v40, a4
    v_accvgpr_read_b32 v44, a148
    v_accvgpr_read_b32 v41, a5
    v_accvgpr_read_b32 v45, a149
    v_accvgpr_read_b32 v42, a6
    v_accvgpr_read_b32 v46, a150
    v_accvgpr_read_b32 v43, a7
    v_accvgpr_read_b32 v47, a151
    v_mul_f32 v40, v40, v44
    v_mul_f32 v41, v41, v45
    v_mul_f32 v42, v42, v46
    v_mul_f32 v43, v43, v47
    v_cvt_pk_bf16_f32 v48, v40, v41
    v_cvt_pk_bf16_f32 v49, v42, v43
    ds_write_b64 v9, v[48:49] offset:4864
    v_accvgpr_read_b32 v40, a20
    v_accvgpr_read_b32 v44, a164
    v_accvgpr_read_b32 v41, a21
    v_accvgpr_read_b32 v45, a165
    v_accvgpr_read_b32 v42, a22
    v_accvgpr_read_b32 v46, a166
    v_accvgpr_read_b32 v43, a23
    v_accvgpr_read_b32 v47, a167
    v_mul_f32 v40, v40, v44
    v_mul_f32 v41, v41, v45
    v_mul_f32 v42, v42, v46
    v_mul_f32 v43, v43, v47
    v_cvt_pk_bf16_f32 v50, v40, v41
    v_cvt_pk_bf16_f32 v51, v42, v43
    ds_write_b64 v9, v[50:51] offset:4896
    v_accvgpr_read_b32 v40, a36
    v_accvgpr_read_b32 v44, a180
    v_accvgpr_read_b32 v41, a37
    v_accvgpr_read_b32 v45, a181
    v_accvgpr_read_b32 v42, a38
    v_accvgpr_read_b32 v46, a182
    v_accvgpr_read_b32 v43, a39
    v_accvgpr_read_b32 v47, a183
    v_mul_f32 v40, v40, v44
    v_mul_f32 v41, v41, v45
    v_mul_f32 v42, v42, v46
    v_mul_f32 v43, v43, v47
    v_cvt_pk_bf16_f32 v52, v40, v41
    v_cvt_pk_bf16_f32 v53, v42, v43
    ds_write_b64 v9, v[52:53] offset:4928
    v_accvgpr_read_b32 v40, a52
    v_accvgpr_read_b32 v44, a196
    v_accvgpr_read_b32 v41, a53
    v_accvgpr_read_b32 v45, a197
    v_accvgpr_read_b32 v42, a54
    v_accvgpr_read_b32 v46, a198
    v_accvgpr_read_b32 v43, a55
    v_accvgpr_read_b32 v47, a199
    v_mul_f32 v40, v40, v44
    v_mul_f32 v41, v41, v45
    v_mul_f32 v42, v42, v46
    v_mul_f32 v43, v43, v47
    v_cvt_pk_bf16_f32 v54, v40, v41
    v_cvt_pk_bf16_f32 v55, v42, v43
    ds_write_b64 v9, v[54:55] offset:4960
    v_accvgpr_read_b32 v40, a68
    v_accvgpr_read_b32 v44, a212
    v_accvgpr_read_b32 v41, a69
    v_accvgpr_read_b32 v45, a213
    v_accvgpr_read_b32 v42, a70
    v_accvgpr_read_b32 v46, a214
    v_accvgpr_read_b32 v43, a71
    v_accvgpr_read_b32 v47, a215
    v_mul_f32 v40, v40, v44
    v_mul_f32 v41, v41, v45
    v_mul_f32 v42, v42, v46
    v_mul_f32 v43, v43, v47
    v_cvt_pk_bf16_f32 v48, v40, v41
    v_cvt_pk_bf16_f32 v49, v42, v43
    ds_write_b64 v9, v[48:49] offset:4992
    v_accvgpr_read_b32 v40, a84
    v_accvgpr_read_b32 v44, a228
    v_accvgpr_read_b32 v41, a85
    v_accvgpr_read_b32 v45, a229
    v_accvgpr_read_b32 v42, a86
    v_accvgpr_read_b32 v46, a230
    v_accvgpr_read_b32 v43, a87
    v_accvgpr_read_b32 v47, a231
    v_mul_f32 v40, v40, v44
    v_mul_f32 v41, v41, v45
    v_mul_f32 v42, v42, v46
    v_mul_f32 v43, v43, v47
    v_cvt_pk_bf16_f32 v50, v40, v41
    v_cvt_pk_bf16_f32 v51, v42, v43
    ds_write_b64 v9, v[50:51] offset:5024
    v_accvgpr_read_b32 v40, a100
    v_accvgpr_read_b32 v44, a244
    v_accvgpr_read_b32 v41, a101
    v_accvgpr_read_b32 v45, a245
    v_accvgpr_read_b32 v42, a102
    v_accvgpr_read_b32 v46, a246
    v_accvgpr_read_b32 v43, a103
    v_accvgpr_read_b32 v47, a247
    v_mul_f32 v40, v40, v44
    v_mul_f32 v41, v41, v45
    v_mul_f32 v42, v42, v46
    v_mul_f32 v43, v43, v47
    v_cvt_pk_bf16_f32 v52, v40, v41
    v_cvt_pk_bf16_f32 v53, v42, v43
    ds_write_b64 v9, v[52:53] offset:5056
    v_accvgpr_read_b32 v40, a116
    v_mov_b32 v44, v228
    v_accvgpr_read_b32 v41, a117
    v_mov_b32 v45, v229
    v_accvgpr_read_b32 v42, a118
    v_mov_b32 v46, v230
    v_accvgpr_read_b32 v43, a119
    v_mov_b32 v47, v231
    v_mul_f32 v40, v40, v44
    v_mul_f32 v41, v41, v45
    v_mul_f32 v42, v42, v46
    v_mul_f32 v43, v43, v47
    v_cvt_pk_bf16_f32 v54, v40, v41
    v_cvt_pk_bf16_f32 v55, v42, v43
    ds_write_b64 v9, v[54:55] offset:5088
    v_accvgpr_read_b32 v40, a132
    v_mov_b32 v44, v244
    v_accvgpr_read_b32 v41, a133
    v_mov_b32 v45, v245
    v_accvgpr_read_b32 v42, a134
    v_mov_b32 v46, v246
    v_accvgpr_read_b32 v43, a135
    v_mov_b32 v47, v247
    v_mul_f32 v40, v40, v44
    v_mul_f32 v41, v41, v45
    v_mul_f32 v42, v42, v46
    v_mul_f32 v43, v43, v47
    v_cvt_pk_bf16_f32 v48, v40, v41
    v_cvt_pk_bf16_f32 v49, v42, v43
    ds_write_b64 v9, v[48:49] offset:5120
    v_accvgpr_read_b32 v40, a8
    v_accvgpr_read_b32 v44, a152
    v_accvgpr_read_b32 v41, a9
    v_accvgpr_read_b32 v45, a153
    v_accvgpr_read_b32 v42, a10
    v_accvgpr_read_b32 v46, a154
    v_accvgpr_read_b32 v43, a11
    v_accvgpr_read_b32 v47, a155
    v_mul_f32 v40, v40, v44
    v_mul_f32 v41, v41, v45
    v_mul_f32 v42, v42, v46
    v_mul_f32 v43, v43, v47
    v_cvt_pk_bf16_f32 v48, v40, v41
    v_cvt_pk_bf16_f32 v49, v42, v43
    ds_write_b64 v9, v[48:49] offset:9728
    v_accvgpr_read_b32 v40, a24
    v_accvgpr_read_b32 v44, a168
    v_accvgpr_read_b32 v41, a25
    v_accvgpr_read_b32 v45, a169
    v_accvgpr_read_b32 v42, a26
    v_accvgpr_read_b32 v46, a170
    v_accvgpr_read_b32 v43, a27
    v_accvgpr_read_b32 v47, a171
    v_mul_f32 v40, v40, v44
    v_mul_f32 v41, v41, v45
    v_mul_f32 v42, v42, v46
    v_mul_f32 v43, v43, v47
    v_cvt_pk_bf16_f32 v50, v40, v41
    v_cvt_pk_bf16_f32 v51, v42, v43
    ds_write_b64 v9, v[50:51] offset:9760
    v_accvgpr_read_b32 v40, a40
    v_accvgpr_read_b32 v44, a184
    v_accvgpr_read_b32 v41, a41
    v_accvgpr_read_b32 v45, a185
    v_accvgpr_read_b32 v42, a42
    v_accvgpr_read_b32 v46, a186
    v_accvgpr_read_b32 v43, a43
    v_accvgpr_read_b32 v47, a187
    v_mul_f32 v40, v40, v44
    v_mul_f32 v41, v41, v45
    v_mul_f32 v42, v42, v46
    v_mul_f32 v43, v43, v47
    v_cvt_pk_bf16_f32 v52, v40, v41
    v_cvt_pk_bf16_f32 v53, v42, v43
    ds_write_b64 v9, v[52:53] offset:9792
    v_accvgpr_read_b32 v40, a56
    v_accvgpr_read_b32 v44, a200
    v_accvgpr_read_b32 v41, a57
    v_accvgpr_read_b32 v45, a201
    v_accvgpr_read_b32 v42, a58
    v_accvgpr_read_b32 v46, a202
    v_accvgpr_read_b32 v43, a59
    v_accvgpr_read_b32 v47, a203
    v_mul_f32 v40, v40, v44
    v_mul_f32 v41, v41, v45
    v_mul_f32 v42, v42, v46
    v_mul_f32 v43, v43, v47
    v_cvt_pk_bf16_f32 v54, v40, v41
    v_cvt_pk_bf16_f32 v55, v42, v43
    ds_write_b64 v9, v[54:55] offset:9824
    v_accvgpr_read_b32 v40, a72
    v_accvgpr_read_b32 v44, a216
    v_accvgpr_read_b32 v41, a73
    v_accvgpr_read_b32 v45, a217
    v_accvgpr_read_b32 v42, a74
    v_accvgpr_read_b32 v46, a218
    v_accvgpr_read_b32 v43, a75
    v_accvgpr_read_b32 v47, a219
    v_mul_f32 v40, v40, v44
    v_mul_f32 v41, v41, v45
    v_mul_f32 v42, v42, v46
    v_mul_f32 v43, v43, v47
    v_cvt_pk_bf16_f32 v48, v40, v41
    v_cvt_pk_bf16_f32 v49, v42, v43
    ds_write_b64 v9, v[48:49] offset:9856
    v_accvgpr_read_b32 v40, a88
    v_accvgpr_read_b32 v44, a232
    v_accvgpr_read_b32 v41, a89
    v_accvgpr_read_b32 v45, a233
    v_accvgpr_read_b32 v42, a90
    v_accvgpr_read_b32 v46, a234
    v_accvgpr_read_b32 v43, a91
    v_accvgpr_read_b32 v47, a235
    v_mul_f32 v40, v40, v44
    v_mul_f32 v41, v41, v45
    v_mul_f32 v42, v42, v46
    v_mul_f32 v43, v43, v47
    v_cvt_pk_bf16_f32 v50, v40, v41
    v_cvt_pk_bf16_f32 v51, v42, v43
    ds_write_b64 v9, v[50:51] offset:9888
    v_accvgpr_read_b32 v40, a104
    v_accvgpr_read_b32 v44, a248
    v_accvgpr_read_b32 v41, a105
    v_accvgpr_read_b32 v45, a249
    v_accvgpr_read_b32 v42, a106
    v_accvgpr_read_b32 v46, a250
    v_accvgpr_read_b32 v43, a107
    v_accvgpr_read_b32 v47, a251
    v_mul_f32 v40, v40, v44
    v_mul_f32 v41, v41, v45
    v_mul_f32 v42, v42, v46
    v_mul_f32 v43, v43, v47
    v_cvt_pk_bf16_f32 v52, v40, v41
    v_cvt_pk_bf16_f32 v53, v42, v43
    ds_write_b64 v9, v[52:53] offset:9920
    v_accvgpr_read_b32 v40, a120
    v_mov_b32 v44, v232
    v_accvgpr_read_b32 v41, a121
    v_mov_b32 v45, v233
    v_accvgpr_read_b32 v42, a122
    v_mov_b32 v46, v234
    v_accvgpr_read_b32 v43, a123
    v_mov_b32 v47, v235
    v_mul_f32 v40, v40, v44
    v_mul_f32 v41, v41, v45
    v_mul_f32 v42, v42, v46
    v_mul_f32 v43, v43, v47
    v_cvt_pk_bf16_f32 v54, v40, v41
    v_cvt_pk_bf16_f32 v55, v42, v43
    ds_write_b64 v9, v[54:55] offset:9952
    v_accvgpr_read_b32 v40, a136
    v_mov_b32 v44, v248
    v_accvgpr_read_b32 v41, a137
    v_mov_b32 v45, v249
    v_accvgpr_read_b32 v42, a138
    v_mov_b32 v46, v250
    v_accvgpr_read_b32 v43, a139
    v_mov_b32 v47, v251
    v_mul_f32 v40, v40, v44
    v_mul_f32 v41, v41, v45
    v_mul_f32 v42, v42, v46
    v_mul_f32 v43, v43, v47
    v_cvt_pk_bf16_f32 v48, v40, v41
    v_cvt_pk_bf16_f32 v49, v42, v43
    ds_write_b64 v9, v[48:49] offset:9984
    v_accvgpr_read_b32 v40, a12
    v_accvgpr_read_b32 v44, a156
    v_accvgpr_read_b32 v41, a13
    v_accvgpr_read_b32 v45, a157
    v_accvgpr_read_b32 v42, a14
    v_accvgpr_read_b32 v46, a158
    v_accvgpr_read_b32 v43, a15
    v_accvgpr_read_b32 v47, a159
    v_mul_f32 v40, v40, v44
    v_mul_f32 v41, v41, v45
    v_mul_f32 v42, v42, v46
    v_mul_f32 v43, v43, v47
    v_cvt_pk_bf16_f32 v48, v40, v41
    v_cvt_pk_bf16_f32 v49, v42, v43
    ds_write_b64 v9, v[48:49] offset:14592
    v_accvgpr_read_b32 v40, a28
    v_accvgpr_read_b32 v44, a172
    v_accvgpr_read_b32 v41, a29
    v_accvgpr_read_b32 v45, a173
    v_accvgpr_read_b32 v42, a30
    v_accvgpr_read_b32 v46, a174
    v_accvgpr_read_b32 v43, a31
    v_accvgpr_read_b32 v47, a175
    v_mul_f32 v40, v40, v44
    v_mul_f32 v41, v41, v45
    v_mul_f32 v42, v42, v46
    v_mul_f32 v43, v43, v47
    v_cvt_pk_bf16_f32 v50, v40, v41
    v_cvt_pk_bf16_f32 v51, v42, v43
    ds_write_b64 v9, v[50:51] offset:14624
    v_accvgpr_read_b32 v40, a44
    v_accvgpr_read_b32 v44, a188
    v_accvgpr_read_b32 v41, a45
    v_accvgpr_read_b32 v45, a189
    v_accvgpr_read_b32 v42, a46
    v_accvgpr_read_b32 v46, a190
    v_accvgpr_read_b32 v43, a47
    v_accvgpr_read_b32 v47, a191
    v_mul_f32 v40, v40, v44
    v_mul_f32 v41, v41, v45
    v_mul_f32 v42, v42, v46
    v_mul_f32 v43, v43, v47
    v_cvt_pk_bf16_f32 v52, v40, v41
    v_cvt_pk_bf16_f32 v53, v42, v43
    ds_write_b64 v9, v[52:53] offset:14656
    v_accvgpr_read_b32 v40, a60
    v_accvgpr_read_b32 v44, a204
    v_accvgpr_read_b32 v41, a61
    v_accvgpr_read_b32 v45, a205
    v_accvgpr_read_b32 v42, a62
    v_accvgpr_read_b32 v46, a206
    v_accvgpr_read_b32 v43, a63
    v_accvgpr_read_b32 v47, a207
    v_mul_f32 v40, v40, v44
    v_mul_f32 v41, v41, v45
    v_mul_f32 v42, v42, v46
    v_mul_f32 v43, v43, v47
    v_cvt_pk_bf16_f32 v54, v40, v41
    v_cvt_pk_bf16_f32 v55, v42, v43
    ds_write_b64 v9, v[54:55] offset:14688
    v_accvgpr_read_b32 v40, a76
    v_accvgpr_read_b32 v44, a220
    v_accvgpr_read_b32 v41, a77
    v_accvgpr_read_b32 v45, a221
    v_accvgpr_read_b32 v42, a78
    v_accvgpr_read_b32 v46, a222
    v_accvgpr_read_b32 v43, a79
    v_accvgpr_read_b32 v47, a223
    v_mul_f32 v40, v40, v44
    v_mul_f32 v41, v41, v45
    v_mul_f32 v42, v42, v46
    v_mul_f32 v43, v43, v47
    v_cvt_pk_bf16_f32 v48, v40, v41
    v_cvt_pk_bf16_f32 v49, v42, v43
    ds_write_b64 v9, v[48:49] offset:14720
    v_accvgpr_read_b32 v40, a92
    v_accvgpr_read_b32 v44, a236
    v_accvgpr_read_b32 v41, a93
    v_accvgpr_read_b32 v45, a237
    v_accvgpr_read_b32 v42, a94
    v_accvgpr_read_b32 v46, a238
    v_accvgpr_read_b32 v43, a95
    v_accvgpr_read_b32 v47, a239
    v_mul_f32 v40, v40, v44
    v_mul_f32 v41, v41, v45
    v_mul_f32 v42, v42, v46
    v_mul_f32 v43, v43, v47
    v_cvt_pk_bf16_f32 v50, v40, v41
    v_cvt_pk_bf16_f32 v51, v42, v43
    ds_write_b64 v9, v[50:51] offset:14752
    v_accvgpr_read_b32 v40, a108
    v_accvgpr_read_b32 v44, a252
    v_accvgpr_read_b32 v41, a109
    v_accvgpr_read_b32 v45, a253
    v_accvgpr_read_b32 v42, a110
    v_accvgpr_read_b32 v46, a254
    v_accvgpr_read_b32 v43, a111
    v_accvgpr_read_b32 v47, a255
    v_mul_f32 v40, v40, v44
    v_mul_f32 v41, v41, v45
    v_mul_f32 v42, v42, v46
    v_mul_f32 v43, v43, v47
    v_cvt_pk_bf16_f32 v52, v40, v41
    v_cvt_pk_bf16_f32 v53, v42, v43
    ds_write_b64 v9, v[52:53] offset:14784
    v_accvgpr_read_b32 v40, a124
    v_mov_b32 v44, v236
    v_accvgpr_read_b32 v41, a125
    v_mov_b32 v45, v237
    v_accvgpr_read_b32 v42, a126
    v_mov_b32 v46, v238
    v_accvgpr_read_b32 v43, a127
    v_mov_b32 v47, v239
    v_mul_f32 v40, v40, v44
    v_mul_f32 v41, v41, v45
    v_mul_f32 v42, v42, v46
    v_mul_f32 v43, v43, v47
    v_cvt_pk_bf16_f32 v54, v40, v41
    v_cvt_pk_bf16_f32 v55, v42, v43
    ds_write_b64 v9, v[54:55] offset:14816
    v_accvgpr_read_b32 v40, a140
    v_mov_b32 v44, v252
    v_accvgpr_read_b32 v41, a141
    v_mov_b32 v45, v253
    v_accvgpr_read_b32 v42, a142
    v_mov_b32 v46, v254
    v_accvgpr_read_b32 v43, a143
    v_mov_b32 v47, v255
    v_mul_f32 v40, v40, v44
    v_mul_f32 v41, v41, v45
    v_mul_f32 v42, v42, v46
    v_mul_f32 v43, v43, v47
    v_cvt_pk_bf16_f32 v48, v40, v41
    v_cvt_pk_bf16_f32 v49, v42, v43
    ds_write_b64 v9, v[48:49] offset:14848
    s_waitcnt lgkmcnt(0)
    s_barrier
    s_mul_i32 s34, s20, 9216
    s_lshl_b32 s35, s21, 1
    s_add_u32 s34, s34, s35
    v_add_u32 v5, 0, v0
    s_mov_b32 s35, 58255
    v_mul_lo_u32 v6, v5, s35
    v_lshrrev_b32 v6, 20, v6
    v_mul_u32_u24 v7, 18, v6
    v_sub_u32 v7, v5, v7
    v_lshlrev_b32 v7, 4, v7
    v_mul_u32_u24 v5, 304, v6
    v_add_u32 v5, v5, v7
    ds_read_b128 v[40:43], v5
    s_mov_b32 s35, 9216
    v_mul_lo_u32 v6, v6, s35
    v_add_u32 v72, v6, v7
    v_add_u32 v5, 256, v0
    s_mov_b32 s35, 58255
    v_mul_lo_u32 v6, v5, s35
    v_lshrrev_b32 v6, 20, v6
    v_mul_u32_u24 v7, 18, v6
    v_sub_u32 v7, v5, v7
    v_lshlrev_b32 v7, 4, v7
    v_mul_u32_u24 v5, 304, v6
    v_add_u32 v5, v5, v7
    ds_read_b128 v[44:47], v5
    s_mov_b32 s35, 9216
    v_mul_lo_u32 v6, v6, s35
    v_add_u32 v73, v6, v7
    v_add_u32 v5, 512, v0
    s_mov_b32 s35, 58255
    v_mul_lo_u32 v6, v5, s35
    v_lshrrev_b32 v6, 20, v6
    v_mul_u32_u24 v7, 18, v6
    v_sub_u32 v7, v5, v7
    v_lshlrev_b32 v7, 4, v7
    v_mul_u32_u24 v5, 304, v6
    v_add_u32 v5, v5, v7
    ds_read_b128 v[48:51], v5
    s_mov_b32 s35, 9216
    v_mul_lo_u32 v6, v6, s35
    v_add_u32 v74, v6, v7
    v_add_u32 v5, 768, v0
    s_mov_b32 s35, 58255
    v_mul_lo_u32 v6, v5, s35
    v_lshrrev_b32 v6, 20, v6
    v_mul_u32_u24 v7, 18, v6
    v_sub_u32 v7, v5, v7
    v_lshlrev_b32 v7, 4, v7
    v_mul_u32_u24 v5, 304, v6
    v_add_u32 v5, v5, v7
    ds_read_b128 v[52:55], v5
    s_mov_b32 s35, 9216
    v_mul_lo_u32 v6, v6, s35
    v_add_u32 v75, v6, v7
    v_add_u32 v5, 1024, v0
    s_mov_b32 s35, 58255
    v_mul_lo_u32 v6, v5, s35
    v_lshrrev_b32 v6, 20, v6
    v_mul_u32_u24 v7, 18, v6
    v_sub_u32 v7, v5, v7
    v_lshlrev_b32 v7, 4, v7
    v_mul_u32_u24 v5, 304, v6
    v_add_u32 v5, v5, v7
    ds_read_b128 v[56:59], v5
    s_mov_b32 s35, 9216
    v_mul_lo_u32 v6, v6, s35
    v_add_u32 v76, v6, v7
    v_add_u32 v5, 1280, v0
    s_mov_b32 s35, 58255
    v_mul_lo_u32 v6, v5, s35
    v_lshrrev_b32 v6, 20, v6
    v_mul_u32_u24 v7, 18, v6
    v_sub_u32 v7, v5, v7
    v_lshlrev_b32 v7, 4, v7
    v_mul_u32_u24 v5, 304, v6
    v_add_u32 v5, v5, v7
    ds_read_b128 v[60:63], v5
    s_mov_b32 s35, 9216
    v_mul_lo_u32 v6, v6, s35
    v_add_u32 v77, v6, v7
    v_add_u32 v5, 1536, v0
    s_mov_b32 s35, 58255
    v_mul_lo_u32 v6, v5, s35
    v_lshrrev_b32 v6, 20, v6
    v_mul_u32_u24 v7, 18, v6
    v_sub_u32 v7, v5, v7
    v_lshlrev_b32 v7, 4, v7
    v_mul_u32_u24 v5, 304, v6
    v_add_u32 v5, v5, v7
    ds_read_b128 v[64:67], v5
    s_mov_b32 s35, 9216
    v_mul_lo_u32 v6, v6, s35
    v_add_u32 v78, v6, v7
    v_add_u32 v5, 1792, v0
    s_mov_b32 s35, 58255
    v_mul_lo_u32 v6, v5, s35
    v_lshrrev_b32 v6, 20, v6
    v_mul_u32_u24 v7, 18, v6
    v_sub_u32 v7, v5, v7
    v_lshlrev_b32 v7, 4, v7
    v_mul_u32_u24 v5, 304, v6
    v_add_u32 v5, v5, v7
    ds_read_b128 v[68:71], v5
    s_mov_b32 s35, 9216
    v_mul_lo_u32 v6, v6, s35
    v_add_u32 v79, v6, v7
    s_waitcnt lgkmcnt(0)
    buffer_store_dwordx4 v[40:43], v72, s[56:59], s34 offen
    buffer_store_dwordx4 v[44:47], v73, s[56:59], s34 offen
    buffer_store_dwordx4 v[48:51], v74, s[56:59], s34 offen
    buffer_store_dwordx4 v[52:55], v75, s[56:59], s34 offen
    buffer_store_dwordx4 v[56:59], v76, s[56:59], s34 offen
    buffer_store_dwordx4 v[60:63], v77, s[56:59], s34 offen
    buffer_store_dwordx4 v[64:67], v78, s[56:59], s34 offen
    buffer_store_dwordx4 v[68:71], v79, s[56:59], s34 offen
    s_nop 1
    v_add_u32 v5, 2048, v0
    s_mov_b32 s35, 58255
    v_mul_lo_u32 v6, v5, s35
    v_lshrrev_b32 v6, 20, v6
    v_mul_u32_u24 v7, 18, v6
    v_sub_u32 v7, v5, v7
    v_lshlrev_b32 v7, 4, v7
    v_mul_u32_u24 v5, 304, v6
    v_add_u32 v5, v5, v7
    ds_read_b128 v[40:43], v5
    s_mov_b32 s35, 9216
    v_mul_lo_u32 v6, v6, s35
    v_add_u32 v72, v6, v7
    v_add_u32 v5, 2304, v0
    s_mov_b32 s35, 58255
    v_mul_lo_u32 v6, v5, s35
    v_lshrrev_b32 v6, 20, v6
    v_mul_u32_u24 v7, 18, v6
    v_sub_u32 v7, v5, v7
    v_lshlrev_b32 v7, 4, v7
    v_mul_u32_u24 v5, 304, v6
    v_add_u32 v5, v5, v7
    ds_read_b128 v[44:47], v5
    s_mov_b32 s35, 9216
    v_mul_lo_u32 v6, v6, s35
    v_add_u32 v73, v6, v7
    v_add_u32 v5, 2560, v0
    s_mov_b32 s35, 58255
    v_mul_lo_u32 v6, v5, s35
    v_lshrrev_b32 v6, 20, v6
    v_mul_u32_u24 v7, 18, v6
    v_sub_u32 v7, v5, v7
    v_lshlrev_b32 v7, 4, v7
    v_mul_u32_u24 v5, 304, v6
    v_add_u32 v5, v5, v7
    ds_read_b128 v[48:51], v5
    s_mov_b32 s35, 9216
    v_mul_lo_u32 v6, v6, s35
    v_add_u32 v74, v6, v7
    v_add_u32 v5, 2816, v0
    s_mov_b32 s35, 58255
    v_mul_lo_u32 v6, v5, s35
    v_lshrrev_b32 v6, 20, v6
    v_mul_u32_u24 v7, 18, v6
    v_sub_u32 v7, v5, v7
    v_lshlrev_b32 v7, 4, v7
    v_mul_u32_u24 v5, 304, v6
    v_add_u32 v5, v5, v7
    ds_read_b128 v[52:55], v5
    s_mov_b32 s35, 9216
    v_mul_lo_u32 v6, v6, s35
    v_add_u32 v75, v6, v7
    v_add_u32 v5, 3072, v0
    s_mov_b32 s35, 58255
    v_mul_lo_u32 v6, v5, s35
    v_lshrrev_b32 v6, 20, v6
    v_mul_u32_u24 v7, 18, v6
    v_sub_u32 v7, v5, v7
    v_lshlrev_b32 v7, 4, v7
    v_mul_u32_u24 v5, 304, v6
    v_add_u32 v5, v5, v7
    ds_read_b128 v[56:59], v5
    s_mov_b32 s35, 9216
    v_mul_lo_u32 v6, v6, s35
    v_add_u32 v76, v6, v7
    v_add_u32 v5, 3328, v0
    s_mov_b32 s35, 58255
    v_mul_lo_u32 v6, v5, s35
    v_lshrrev_b32 v6, 20, v6
    v_mul_u32_u24 v7, 18, v6
    v_sub_u32 v7, v5, v7
    v_lshlrev_b32 v7, 4, v7
    v_mul_u32_u24 v5, 304, v6
    v_add_u32 v5, v5, v7
    ds_read_b128 v[60:63], v5
    s_mov_b32 s35, 9216
    v_mul_lo_u32 v6, v6, s35
    v_add_u32 v77, v6, v7
    v_add_u32 v5, 3584, v0
    s_mov_b32 s35, 58255
    v_mul_lo_u32 v6, v5, s35
    v_lshrrev_b32 v6, 20, v6
    v_mul_u32_u24 v7, 18, v6
    v_sub_u32 v7, v5, v7
    v_lshlrev_b32 v7, 4, v7
    v_mul_u32_u24 v5, 304, v6
    v_add_u32 v5, v5, v7
    ds_read_b128 v[64:67], v5
    s_mov_b32 s35, 9216
    v_mul_lo_u32 v6, v6, s35
    v_add_u32 v78, v6, v7
    v_add_u32 v5, 3840, v0
    s_mov_b32 s35, 58255
    v_mul_lo_u32 v6, v5, s35
    v_lshrrev_b32 v6, 20, v6
    v_mul_u32_u24 v7, 18, v6
    v_sub_u32 v7, v5, v7
    v_lshlrev_b32 v7, 4, v7
    v_mul_u32_u24 v5, 304, v6
    v_add_u32 v5, v5, v7
    ds_read_b128 v[68:71], v5
    s_mov_b32 s35, 9216
    v_mul_lo_u32 v6, v6, s35
    v_add_u32 v79, v6, v7
    s_waitcnt lgkmcnt(0)
    buffer_store_dwordx4 v[40:43], v72, s[56:59], s34 offen
    buffer_store_dwordx4 v[44:47], v73, s[56:59], s34 offen
    buffer_store_dwordx4 v[48:51], v74, s[56:59], s34 offen
    buffer_store_dwordx4 v[52:55], v75, s[56:59], s34 offen
    buffer_store_dwordx4 v[56:59], v76, s[56:59], s34 offen
    buffer_store_dwordx4 v[60:63], v77, s[56:59], s34 offen
    buffer_store_dwordx4 v[64:67], v78, s[56:59], s34 offen
    buffer_store_dwordx4 v[68:71], v79, s[56:59], s34 offen
    s_nop 1
    v_add_u32 v5, 4096, v0
    s_mov_b32 s35, 58255
    v_mul_lo_u32 v6, v5, s35
    v_lshrrev_b32 v6, 20, v6
    v_mul_u32_u24 v7, 18, v6
    v_sub_u32 v7, v5, v7
    v_lshlrev_b32 v7, 4, v7
    v_mul_u32_u24 v5, 304, v6
    v_add_u32 v5, v5, v7
    ds_read_b128 v[40:43], v5
    s_mov_b32 s35, 9216
    v_mul_lo_u32 v6, v6, s35
    v_add_u32 v72, v6, v7
    v_add_u32 v5, 4352, v0
    s_mov_b32 s35, 58255
    v_mul_lo_u32 v6, v5, s35
    v_lshrrev_b32 v6, 20, v6
    v_mul_u32_u24 v7, 18, v6
    v_sub_u32 v7, v5, v7
    v_lshlrev_b32 v7, 4, v7
    v_mul_u32_u24 v5, 304, v6
    v_add_u32 v5, v5, v7
    ds_read_b128 v[44:47], v5
    s_mov_b32 s35, 9216
    v_mul_lo_u32 v6, v6, s35
    v_add_u32 v73, v6, v7
    s_waitcnt lgkmcnt(0)
    buffer_store_dwordx4 v[40:43], v72, s[56:59], s34 offen
    buffer_store_dwordx4 v[44:47], v73, s[56:59], s34 offen
    s_nop 1
k4_end:
    s_endpgm

.globl k5_kernel
.p2align 8
.type k5_kernel,@function
k5_kernel:
    s_cmp_ge_u32 s2, 256
    s_cbranch_scc1 k5_end
    s_load_dwordx2 s[6:7], s[0:1], 48
    s_load_dwordx2 s[8:9], s[0:1], 88
    s_waitcnt lgkmcnt(0)
    s_add_u32 s40, s8, 0x1400000
    s_addc_u32 s41, s9, 0
    s_and_b32 s41, s41, 0xffff
    s_mov_b32 s42, 0x1200000
    s_mov_b32 s43, 0x00020000
    s_mov_b32 s44, s6
    s_mov_b32 s45, s7
    s_and_b32 s45, s45, 0xffff
    s_mov_b32 s46, 0x510000
    s_mov_b32 s47, 0x00020000
    s_add_u32 s56, s8, 0x2800000
    s_addc_u32 s57, s9, 0
    s_and_b32 s57, s57, 0xffff
    s_mov_b32 s58, 0x1200000
    s_mov_b32 s59, 0x00020000
    s_and_b32 s12, s2, 3
    s_lshr_b32 s10, s2, 4
    s_bfe_u32 s11, s2, 0x20002
    s_lshl_b32 s20, s10, 7
    s_mul_i32 s21, s11, 144
    s_mul_i32 s22, s12, 1152
    v_and_b32 v1, 63, v0
    v_lshrrev_b32 v2, 6, v0
    s_nop 0
    v_readfirstlane_b32 s23, v2
    s_mov_b32 s24, 0
    s_mov_b32 s25, s23
    s_mov_b32 s26, 9216
    s_mul_i32 s27, s23, 32
    v_lshrrev_b32 v3, 3, v1
    v_add_u32 v3, 0, v3
    v_add_u32 v3, s27, v3
    v_lshrrev_b32 v4, 1, v3
    v_and_b32 v4, 7, v4
    v_and_b32 v5, 7, v1
    v_xor_b32 v4, v4, v5
    v_add_u32 v3, s20, v3
    v_mul_lo_u32 v8, v3, s26
    v_lshlrev_b32 v4, 4, v4
    v_add_u32 v8, v8, v4
    v_lshrrev_b32 v3, 3, v1
    v_add_u32 v3, 8, v3
    v_add_u32 v3, s27, v3
    v_lshrrev_b32 v4, 1, v3
    v_and_b32 v4, 7, v4
    v_and_b32 v5, 7, v1
    v_xor_b32 v4, v4, v5
    v_add_u32 v3, s20, v3
    v_mul_lo_u32 v9, v3, s26
    v_lshlrev_b32 v4, 4, v4
    v_add_u32 v9, v9, v4
    v_lshrrev_b32 v3, 3, v1
    v_add_u32 v3, 16, v3
    v_add_u32 v3, s27, v3
    v_lshrrev_b32 v4, 1, v3
    v_and_b32 v4, 7, v4
    v_and_b32 v5, 7, v1
    v_xor_b32 v4, v4, v5
    v_add_u32 v3, s20, v3
    v_mul_lo_u32 v10, v3, s26
    v_lshlrev_b32 v4, 4, v4
    v_add_u32 v10, v10, v4
    v_lshrrev_b32 v3, 3, v1
    v_add_u32 v3, 24, v3
    v_add_u32 v3, s27, v3
    v_lshrrev_b32 v4, 1, v3
    v_and_b32 v4, 7, v4
    v_and_b32 v5, 7, v1
    v_xor_b32 v4, v4, v5
    v_add_u32 v3, s20, v3
    v_mul_lo_u32 v11, v3, s26
    v_lshlrev_b32 v4, 4, v4
    v_add_u32 v11, v11, v4
    s_mov_b32 s27, 1152
    s_lshl_b32 s28, s21, 1
    s_add_u32 s29, s23, 0
    s_min_u32 s29, s29, 17
    s_lshl_b32 s29, s29, 6
    v_add_u32 v5, s29, v1
    s_mov_b32 s29, 3641
    v_mul_lo_u32 v6, v5, s29
    v_lshrrev_b32 v6, 16, v6
    v_mul_u32_u24 v7, 18, v6
    v_sub_u32 v7, v5, v7
    v_and_b32 v3, 32, v6
    v_bfe_u32 v4, v6, 4, 1
    v_lshlrev_b32 v4, 2, v4
    v_add_u32 v3, v3, v4
    v_bfe_u32 v4, v6, 2, 2
    v_lshlrev_b32 v4, 3, v4
    v_add_u32 v3, v3, v4
    v_and_b32 v4, 3, v6
    v_add_u32 v3, v3, v4
    v_mul_lo_u32 v17, v3, s27
    v_lshlrev_b32 v7, 4, v7
    v_add_u32 v17, v17, v7
    v_add_u32 v17, s28, v17
    s_add_u32 s29, s23, 4
    s_min_u32 s29, s29, 17
    s_lshl_b32 s29, s29, 6
    v_add_u32 v5, s29, v1
    s_mov_b32 s29, 3641
    v_mul_lo_u32 v6, v5, s29
    v_lshrrev_b32 v6, 16, v6
    v_mul_u32_u24 v7, 18, v6
    v_sub_u32 v7, v5, v7
    v_and_b32 v3, 32, v6
    v_bfe_u32 v4, v6, 4, 1
    v_lshlrev_b32 v4, 2, v4
    v_add_u32 v3, v3, v4
    v_bfe_u32 v4, v6, 2, 2
    v_lshlrev_b32 v4, 3, v4
    v_add_u32 v3, v3, v4
    v_and_b32 v4, 3, v6
    v_add_u32 v3, v3, v4
    v_mul_lo_u32 v18, v3, s27
    v_lshlrev_b32 v7, 4, v7
    v_add_u32 v18, v18, v7
    v_add_u32 v18, s28, v18
    s_add_u32 s29, s23, 8
    s_min_u32 s29, s29, 17
    s_lshl_b32 s29, s29, 6
    v_add_u32 v5, s29, v1
    s_mov_b32 s29, 3641
    v_mul_lo_u32 v6, v5, s29
    v_lshrrev_b32 v6, 16, v6
    v_mul_u32_u24 v7, 18, v6
    v_sub_u32 v7, v5, v7
    v_and_b32 v3, 32, v6
    v_bfe_u32 v4, v6, 4, 1
    v_lshlrev_b32 v4, 2, v4
    v_add_u32 v3, v3, v4
    v_bfe_u32 v4, v6, 2, 2
    v_lshlrev_b32 v4, 3, v4
    v_add_u32 v3, v3, v4
    v_and_b32 v4, 3, v6
    v_add_u32 v3, v3, v4
    v_mul_lo_u32 v19, v3, s27
    v_lshlrev_b32 v7, 4, v7
    v_add_u32 v19, v19, v7
    v_add_u32 v19, s28, v19
    s_add_u32 s29, s23, 12
    s_min_u32 s29, s29, 17
    s_lshl_b32 s29, s29, 6
    v_add_u32 v5, s29, v1
    s_mov_b32 s29, 3641
    v_mul_lo_u32 v6, v5, s29
    v_lshrrev_b32 v6, 16, v6
    v_mul_u32_u24 v7, 18, v6
    v_sub_u32 v7, v5, v7
    v_and_b32 v3, 32, v6
    v_bfe_u32 v4, v6, 4, 1
    v_lshlrev_b32 v4, 2, v4
    v_add_u32 v3, v3, v4
    v_bfe_u32 v4, v6, 2, 2
    v_lshlrev_b32 v4, 3, v4
    v_add_u32 v3, v3, v4
    v_and_b32 v4, 3, v6
    v_add_u32 v3, v3, v4
    v_mul_lo_u32 v20, v3, s27
    v_lshlrev_b32 v7, 4, v7
    v_add_u32 v20, v20, v7
    v_add_u32 v20, s28, v20
    s_add_u32 s29, s23, 16
    s_min_u32 s29, s29, 17
    s_lshl_b32 s29, s29, 6
    v_add_u32 v5, s29, v1
    s_mov_b32 s29, 3641
    v_mul_lo_u32 v6, v5, s29
    v_lshrrev_b32 v6, 16, v6
    v_mul_u32_u24 v7, 18, v6
    v_sub_u32 v7, v5, v7
    v_and_b32 v3, 32, v6
    v_bfe_u32 v4, v6, 4, 1
    v_lshlrev_b32 v4, 2, v4
    v_add_u32 v3, v3, v4
    v_bfe_u32 v4, v6, 2, 2
    v_lshlrev_b32 v4, 3, v4
    v_add_u32 v3, v3, v4
    v_and_b32 v4, 3, v6
    v_add_u32 v3, v3, v4
    v_mul_lo_u32 v21, v3, s27
    v_lshlrev_b32 v7, 4, v7
    v_add_u32 v21, v21, v7
    v_add_u32 v21, s28, v21
    v_and_b32 v5, 15, v1
    v_lshrrev_b32 v6, 4, v1
    v_lshrrev_b32 v7, 1, v5
    v_xor_b32 v7, v7, v6
    s_lshl_b32 s26, s25, 12
    v_lshlrev_b32 v27, 7, v5
    v_add_u32 v27, s26, v27
    v_xor_b32 v28, 4, v7
    v_lshlrev_b32 v28, 4, v28
    v_add_u32 v28, v27, v28
    v_lshlrev_b32 v7, 4, v7
    v_add_u32 v27, v27, v7
    v_and_b32 v5, 15, v1
    v_lshrrev_b32 v6, 4, v1
    v_lshrrev_b32 v7, 2, v5
    v_lshlrev_b32 v31, 2, v6
    v_add_u32 v31, v31, v7
    v_mul_u32_u24 v31, 288, v31
    v_and_b32 v5, 3, v5
    v_lshlrev_b32 v5, 3, v5
    v_add_u32 v31, v31, v5
    v_add_u32 v31, 16384, v31
    s_mov_b32 s70, 0
    s_mov_b32 s71, 0
    s_mov_b32 s73, 0
    s_min_u32 s72, s70, 17
    s_lshl_b32 s30, s72, 6
    s_add_u32 s30, s30, s22
    s_mul_i32 s31, s30, 1152
    s_lshl_b32 s30, s30, 1
    s_mul_i32 s32, s23, 4096
    s_add_u32 s32, s32, s71
    s_add_u32 m0, s32, 0
    s_nop 0
    buffer_load_dwordx4 v8, s[40:43], s30 offen lds
    s_add_u32 m0, s32, 1024
    s_nop 0
    buffer_load_dwordx4 v9, s[40:43], s30 offen lds
    s_add_u32 m0, s32, 2048
    s_nop 0
    buffer_load_dwordx4 v10, s[40:43], s30 offen lds
    s_add_u32 m0, s32, 3072
    s_nop 0
    buffer_load_dwordx4 v11, s[40:43], s30 offen lds
    s_add_u32 s33, s23, 0
    s_min_u32 s33, s33, 17
    s_lshl_b32 s33, s33, 10
    s_add_u32 s33, s33, s71
    s_add_u32 m0, s33, 16384
    s_nop 0
    buffer_load_dwordx4 v17, s[44:47], s31 offen lds
    s_add_u32 s33, s23, 4
    s_min_u32 s33, s33, 17
    s_lshl_b32 s33, s33, 10
    s_add_u32 s33, s33, s71
    s_add_u32 m0, s33, 16384
    s_nop 0
    buffer_load_dwordx4 v18, s[44:47], s31 offen lds
    s_add_u32 s33, s23, 8
    s_min_u32 s33, s33, 17
    s_lshl_b32 s33, s33, 10
    s_add_u32 s33, s33, s71
    s_add_u32 m0, s33, 16384
    s_nop 0
    buffer_load_dwordx4 v19, s[44:47], s31 offen lds
    s_add_u32 s33, s23, 12
    s_min_u32 s33, s33, 17
    s_lshl_b32 s33, s33, 10
    s_add_u32 s33, s33, s71
    s_add_u32 m0, s33, 16384
    s_nop 0
    buffer_load_dwordx4 v20, s[44:47], s31 offen lds
    s_add_u32 s33, s23, 16
    s_min_u32 s33, s33, 17
    s_lshl_b32 s33, s33, 10
    s_add_u32 s33, s33, s71
    s_add_u32 m0, s33, 16384
    s_nop 0
    buffer_load_dwordx4 v21, s[44:47], s31 offen lds
    s_add_u32 s70, s70, 1
    s_add_u32 s71, s71, 34816
    s_cmp_ge_u32 s71, 139264
    s_cselect_b32 s71, 0, s71
    s_min_u32 s72, s70, 17
    s_lshl_b32 s30, s72, 6
    s_add_u32 s30, s30, s22
    s_mul_i32 s31, s30, 1152
    s_lshl_b32 s30, s30, 1
    s_mul_i32 s32, s23, 4096
    s_add_u32 s32, s32, s71
    s_add_u32 m0, s32, 0
    s_nop 0
    buffer_load_dwordx4 v8, s[40:43], s30 offen lds
    s_add_u32 m0, s32, 1024
    s_nop 0
    buffer_load_dwordx4 v9, s[40:43], s30 offen lds
    s_add_u32 m0, s32, 2048
    s_nop 0
    buffer_load_dwordx4 v10, s[40:43], s30 offen lds
    s_add_u32 m0, s32, 3072
    s_nop 0
    buffer_load_dwordx4 v11, s[40:43], s30 offen lds
    s_add_u32 s33, s23, 0
    s_min_u32 s33, s33, 17
    s_lshl_b32 s33, s33, 10
    s_add_u32 s33, s33, s71
    s_add_u32 m0, s33, 16384
    s_nop 0
    buffer_load_dwordx4 v17, s[44:47], s31 offen lds
    s_add_u32 s33, s23, 4
    s_min_u32 s33, s33, 17
    s_lshl_b32 s33, s33, 10
    s_add_u32 s33, s33, s71
    s_add_u32 m0, s33, 16384
    s_nop 0
    buffer_load_dwordx4 v18, s[44:47], s31 offen lds
    s_add_u32 s33, s23, 8
    s_min_u32 s33, s33, 17
    s_lshl_b32 s33, s33, 10
    s_add_u32 s33, s33, s71
    s_add_u32 m0, s33, 16384
    s_nop 0
    buffer_load_dwordx4 v19, s[44:47], s31 offen lds
    s_add_u32 s33, s23, 12
    s_min_u32 s33, s33, 17
    s_lshl_b32 s33, s33, 10
    s_add_u32 s33, s33, s71
    s_add_u32 m0, s33, 16384
    s_nop 0
    buffer_load_dwordx4 v20, s[44:47], s31 offen lds
    s_add_u32 s33, s23, 16
    s_min_u32 s33, s33, 17
    s_lshl_b32 s33, s33, 10
    s_add_u32 s33, s33, s71
    s_add_u32 m0, s33, 16384
    s_nop 0
    buffer_load_dwordx4 v21, s[44:47], s31 offen lds
    s_add_u32 s70, s70, 1
    s_add_u32 s71, s71, 34816
    s_cmp_ge_u32 s71, 139264
    s_cselect_b32 s71, 0, s71
    s_min_u32 s72, s70, 17
    s_lshl_b32 s30, s72, 6
    s_add_u32 s30, s30, s22
    s_mul_i32 s31, s30, 1152
    s_lshl_b32 s30, s30, 1
    s_mul_i32 s32, s23, 4096
    s_add_u32 s32, s32, s71
    s_add_u32 m0, s32, 0
    s_nop 0
    buffer_load_dwordx4 v8, s[40:43], s30 offen lds
    s_add_u32 m0, s32, 1024
    s_nop 0
    buffer_load_dwordx4 v9, s[40:43], s30 offen lds
    s_add_u32 m0, s32, 2048
    s_nop 0
    buffer_load_dwordx4 v10, s[40:43], s30 offen lds
    s_add_u32 m0, s32, 3072
    s_nop 0
    buffer_load_dwordx4 v11, s[40:43], s30 offen lds
    s_add_u32 s33, s23, 0
    s_min_u32 s33, s33, 17
    s_lshl_b32 s33, s33, 10
    s_add_u32 s33, s33, s71
    s_add_u32 m0, s33, 16384
    s_nop 0
    buffer_load_dwordx4 v17, s[44:47], s31 offen lds
    s_add_u32 s33, s23, 4
    s_min_u32 s33, s33, 17
    s_lshl_b32 s33, s33, 10
    s_add_u32 s33, s33, s71
    s_add_u32 m0, s33, 16384
    s_nop 0
    buffer_load_dwordx4 v18, s[44:47], s31 offen lds
    s_add_u32 s33, s23, 8
    s_min_u32 s33, s33, 17
    s_lshl_b32 s33, s33, 10
    s_add_u32 s33, s33, s71
    s_add_u32 m0, s33, 16384
    s_nop 0
    buffer_load_dwordx4 v19, s[44:47], s31 offen lds
    s_add_u32 s33, s23, 12
    s_min_u32 s33, s33, 17
    s_lshl_b32 s33, s33, 10
    s_add_u32 s33, s33, s71
    s_add_u32 m0, s33, 16384
    s_nop 0
    buffer_load_dwordx4 v20, s[44:47], s31 offen lds
    s_add_u32 s33, s23, 16
    s_min_u32 s33, s33, 17
    s_lshl_b32 s33, s33, 10
    s_add_u32 s33, s33, s71
    s_add_u32 m0, s33, 16384
    s_nop 0
    buffer_load_dwordx4 v21, s[44:47], s31 offen lds
    s_add_u32 s70, s70, 1
    s_add_u32 s71, s71, 34816
    s_cmp_ge_u32 s71, 139264
    s_cselect_b32 s71, 0, s71
    v_mov_b32 v96, 0
    v_mov_b32 v97, 0
    v_mov_b32 v98, 0
    v_mov_b32 v99, 0
    v_mov_b32 v100, 0
    v_mov_b32 v101, 0
    v_mov_b32 v102, 0
    v_mov_b32 v103, 0
    v_mov_b32 v104, 0
    v_mov_b32 v105, 0
    v_mov_b32 v106, 0
    v_mov_b32 v107, 0
    v_mov_b32 v108, 0
    v_mov_b32 v109, 0
    v_mov_b32 v110, 0
    v_mov_b32 v111, 0
    v_mov_b32 v112, 0
    v_mov_b32 v113, 0
    v_mov_b32 v114, 0
    v_mov_b32 v115, 0
    v_mov_b32 v116, 0
    v_mov_b32 v117, 0
    v_mov_b32 v118, 0
    v_mov_b32 v119, 0
    v_mov_b32 v120, 0
    v_mov_b32 v121, 0
    v_mov_b32 v122, 0
    v_mov_b32 v123, 0
    v_mov_b32 v124, 0
    v_mov_b32 v125, 0
    v_mov_b32 v126, 0
    v_mov_b32 v127, 0
    v_mov_b32 v128, 0
    v_mov_b32 v129, 0
    v_mov_b32 v130, 0
    v_mov_b32 v131, 0
    v_mov_b32 v132, 0
    v_mov_b32 v133, 0
    v_mov_b32 v134, 0
    v_mov_b32 v135, 0
    v_mov_b32 v136, 0
    v_mov_b32 v137, 0
    v_mov_b32 v138, 0
    v_mov_b32 v139, 0
    v_mov_b32 v140, 0
    v_mov_b32 v141, 0
    v_mov_b32 v142, 0
    v_mov_b32 v143, 0
    v_mov_b32 v144, 0
    v_mov_b32 v145, 0
    v_mov_b32 v146, 0
    v_mov_b32 v147, 0
    v_mov_b32 v148, 0
    v_mov_b32 v149, 0
    v_mov_b32 v150, 0
    v_mov_b32 v151, 0
    v_mov_b32 v152, 0
    v_mov_b32 v153, 0
    v_mov_b32 v154, 0
    v_mov_b32 v155, 0
    v_mov_b32 v156, 0
    v_mov_b32 v157, 0
    v_mov_b32 v158, 0
    v_mov_b32 v159, 0
    v_mov_b32 v160, 0
    v_mov_b32 v161, 0
    v_mov_b32 v162, 0
    v_mov_b32 v163, 0
    v_mov_b32 v164, 0
    v_mov_b32 v165, 0
    v_mov_b32 v166, 0
    v_mov_b32 v167, 0
    s_mov_b32 s74, 0
kloop_800001:
    s_waitcnt vmcnt(18) lgkmcnt(0)
    s_barrier
    v_add_u32 v33, s73, v27
    v_add_u32 v34, s73, v28
    v_add_u32 v35, s73, v31
    ds_read_b128 v[40:43], v33 offset:0
    ds_read_b128 v[44:47], v33 offset:2048
    ds_read_b64_tr_b16 v[56:57], v35 offset:0
    ds_read_b64_tr_b16 v[58:59], v35 offset:4608
    ds_read_b64_tr_b16 v[60:61], v35 offset:32
    ds_read_b64_tr_b16 v[62:63], v35 offset:4640
    ds_read_b64_tr_b16 v[64:65], v35 offset:64
    ds_read_b64_tr_b16 v[66:67], v35 offset:4672
    s_waitcnt lgkmcnt(4)
    v_mfma_f32_16x16x32_bf16 v[96:99], v[56:59], v[40:43], v[96:99]
    v_mfma_f32_16x16x32_bf16 v[100:103], v[56:59], v[44:47], v[100:103]
    ds_read_b64_tr_b16 v[68:69], v35 offset:96
    ds_read_b64_tr_b16 v[70:71], v35 offset:4704
    s_min_u32 s72, s70, 17
    s_lshl_b32 s30, s72, 6
    s_add_u32 s30, s30, s22
    s_mul_i32 s31, s30, 1152
    s_lshl_b32 s30, s30, 1
    s_mul_i32 s32, s23, 4096
    s_add_u32 s32, s32, s71
    s_add_u32 m0, s32, 0
    s_nop 0
    buffer_load_dwordx4 v8, s[40:43], s30 offen lds
    s_waitcnt lgkmcnt(4)
    v_mfma_f32_16x16x32_bf16 v[104:107], v[60:63], v[40:43], v[104:107]
    v_mfma_f32_16x16x32_bf16 v[108:111], v[60:63], v[44:47], v[108:111]
    ds_read_b64_tr_b16 v[56:57], v35 offset:128
    ds_read_b64_tr_b16 v[58:59], v35 offset:4736
    s_add_u32 m0, s32, 1024
    s_nop 0
    buffer_load_dwordx4 v9, s[40:43], s30 offen lds
    s_waitcnt lgkmcnt(4)
    v_mfma_f32_16x16x32_bf16 v[112:115], v[64:67], v[40:43], v[112:115]
    v_mfma_f32_16x16x32_bf16 v[116:119], v[64:67], v[44:47], v[116:119]
    ds_read_b64_tr_b16 v[60:61], v35 offset:160
    ds_read_b64_tr_b16 v[62:63], v35 offset:4768
    s_add_u32 m0, s32, 2048
    s_nop 0
    buffer_load_dwordx4 v10, s[40:43], s30 offen lds
    s_waitcnt lgkmcnt(4)
    v_mfma_f32_16x16x32_bf16 v[120:123], v[68:71], v[40:43], v[120:123]
    v_mfma_f32_16x16x32_bf16 v[124:127], v[68:71], v[44:47], v[124:127]
    ds_read_b64_tr_b16 v[64:65], v35 offset:192
    ds_read_b64_tr_b16 v[66:67], v35 offset:4800
    s_add_u32 m0, s32, 3072
    s_nop 0
    buffer_load_dwordx4 v11, s[40:43], s30 offen lds
    s_waitcnt lgkmcnt(4)
    v_mfma_f32_16x16x32_bf16 v[128:131], v[56:59], v[40:43], v[128:131]
    v_mfma_f32_16x16x32_bf16 v[132:135], v[56:59], v[44:47], v[132:135]
    ds_read_b64_tr_b16 v[68:69], v35 offset:224
    ds_read_b64_tr_b16 v[70:71], v35 offset:4832
    s_add_u32 s33, s23, 0
    s_min_u32 s33, s33, 17
    s_lshl_b32 s33, s33, 10
    s_add_u32 s33, s33, s71
    s_add_u32 m0, s33, 16384
    s_nop 0
    buffer_load_dwordx4 v17, s[44:47], s31 offen lds
    s_waitcnt lgkmcnt(4)
    v_mfma_f32_16x16x32_bf16 v[136:139], v[60:63], v[40:43], v[136:139]
    v_mfma_f32_16x16x32_bf16 v[140:143], v[60:63], v[44:47], v[140:143]
    ds_read_b64_tr_b16 v[56:57], v35 offset:256
    ds_read_b64_tr_b16 v[58:59], v35 offset:4864
    s_add_u32 s33, s23, 4
    s_min_u32 s33, s33, 17
    s_lshl_b32 s33, s33, 10
    s_add_u32 s33, s33, s71
    s_add_u32 m0, s33, 16384
    s_nop 0
    buffer_load_dwordx4 v18, s[44:47], s31 offen lds
    s_waitcnt lgkmcnt(4)
    v_mfma_f32_16x16x32_bf16 v[144:147], v[64:67], v[40:43], v[144:147]
    v_mfma_f32_16x16x32_bf16 v[148:151], v[64:67], v[44:47], v[148:151]
    s_add_u32 s33, s23, 8
    s_min_u32 s33, s33, 17
    s_lshl_b32 s33, s33, 10
    s_add_u32 s33, s33, s71
    s_add_u32 m0, s33, 16384
    s_nop 0
    buffer_load_dwordx4 v19, s[44:47], s31 offen lds
    s_waitcnt lgkmcnt(2)
    v_mfma_f32_16x16x32_bf16 v[152:155], v[68:71], v[40:43], v[152:155]
    v_mfma_f32_16x16x32_bf16 v[156:159], v[68:71], v[44:47], v[156:159]
    s_add_u32 s33, s23, 12
    s_min_u32 s33, s33, 17
    s_lshl_b32 s33, s33, 10
    s_add_u32 s33, s33, s71
    s_add_u32 m0, s33, 16384
    s_nop 0
    buffer_load_dwordx4 v20, s[44:47], s31 offen lds
    s_waitcnt lgkmcnt(0)
    v_mfma_f32_16x16x32_bf16 v[160:163], v[56:59], v[40:43], v[160:163]
    v_mfma_f32_16x16x32_bf16 v[164:167], v[56:59], v[44:47], v[164:167]
    s_add_u32 s33, s23, 16
    s_min_u32 s33, s33, 17
    s_lshl_b32 s33, s33, 10
    s_add_u32 s33, s33, s71
    s_add_u32 m0, s33, 16384
    s_nop 0
    buffer_load_dwordx4 v21, s[44:47], s31 offen lds
    ds_read_b128 v[40:43], v34 offset:0
    ds_read_b128 v[44:47], v34 offset:2048
    ds_read_b64_tr_b16 v[56:57], v35 offset:9216
    ds_read_b64_tr_b16 v[58:59], v35 offset:13824
    ds_read_b64_tr_b16 v[60:61], v35 offset:9248
    ds_read_b64_tr_b16 v[62:63], v35 offset:13856
    ds_read_b64_tr_b16 v[64:65], v35 offset:9280
    ds_read_b64_tr_b16 v[66:67], v35 offset:13888
    s_waitcnt lgkmcnt(4)
    v_mfma_f32_16x16x32_bf16 v[96:99], v[56:59], v[40:43], v[96:99]
    v_mfma_f32_16x16x32_bf16 v[100:103], v[56:59], v[44:47], v[100:103]
    ds_read_b64_tr_b16 v[68:69], v35 offset:9312
    ds_read_b64_tr_b16 v[70:71], v35 offset:13920
    s_waitcnt lgkmcnt(4)
    v_mfma_f32_16x16x32_bf16 v[104:107], v[60:63], v[40:43], v[104:107]
    v_mfma_f32_16x16x32_bf16 v[108:111], v[60:63], v[44:47], v[108:111]
    ds_read_b64_tr_b16 v[56:57], v35 offset:9344
    ds_read_b64_tr_b16 v[58:59], v35 offset:13952
    s_waitcnt lgkmcnt(4)
    v_mfma_f32_16x16x32_bf16 v[112:115], v[64:67], v[40:43], v[112:115]
    v_mfma_f32_16x16x32_bf16 v[116:119], v[64:67], v[44:47], v[116:119]
    ds_read_b64_tr_b16 v[60:61], v35 offset:9376
    ds_read_b64_tr_b16 v[62:63], v35 offset:13984
    s_waitcnt lgkmcnt(4)
    v_mfma_f32_16x16x32_bf16 v[120:123], v[68:71], v[40:43], v[120:123]
    v_mfma_f32_16x16x32_bf16 v[124:127], v[68:71], v[44:47], v[124:127]
    ds_read_b64_tr_b16 v[64:65], v35 offset:9408
    ds_read_b64_tr_b16 v[66:67], v35 offset:14016
    s_waitcnt lgkmcnt(4)
    v_mfma_f32_16x16x32_bf16 v[128:131], v[56:59], v[40:43], v[128:131]
    v_mfma_f32_16x16x32_bf16 v[132:135], v[56:59], v[44:47], v[132:135]
    ds_read_b64_tr_b16 v[68:69], v35 offset:9440
    ds_read_b64_tr_b16 v[70:71], v35 offset:14048
    s_waitcnt lgkmcnt(4)
    v_mfma_f32_16x16x32_bf16 v[136:139], v[60:63], v[40:43], v[136:139]
    v_mfma_f32_16x16x32_bf16 v[140:143], v[60:63], v[44:47], v[140:143]
    ds_read_b64_tr_b16 v[56:57], v35 offset:9472
    ds_read_b64_tr_b16 v[58:59], v35 offset:14080
    s_waitcnt lgkmcnt(4)
    v_mfma_f32_16x16x32_bf16 v[144:147], v[64:67], v[40:43], v[144:147]
    v_mfma_f32_16x16x32_bf16 v[148:151], v[64:67], v[44:47], v[148:151]
    s_waitcnt lgkmcnt(2)
    v_mfma_f32_16x16x32_bf16 v[152:155], v[68:71], v[40:43], v[152:155]
    v_mfma_f32_16x16x32_bf16 v[156:159], v[68:71], v[44:47], v[156:159]
    s_waitcnt lgkmcnt(0)
    v_mfma_f32_16x16x32_bf16 v[160:163], v[56:59], v[40:43], v[160:163]
    v_mfma_f32_16x16x32_bf16 v[164:167], v[56:59], v[44:47], v[164:167]
    s_add_u32 s70, s70, 1
    s_add_u32 s71, s71, 34816
    s_cmp_ge_u32 s71, 139264
    s_cselect_b32 s71, 0, s71
    s_add_u32 s73, s73, 34816
    s_cmp_ge_u32 s73, 139264
    s_cselect_b32 s73, 0, s73
    s_add_u32 s74, s74, 1
    s_cmp_lt_u32 s74, 18
    s_cbranch_scc1 kloop_800001
    s_waitcnt vmcnt(0)
    s_nop 7
    s_nop 7
    s_barrier
    v_and_b32 v5, 15, v1
    s_lshl_b32 s26, s25, 5
    v_add_u32 v5, s26, v5
    v_mul_u32_u24 v9, 592, v5
    v_lshrrev_b32 v6, 4, v1
    v_lshlrev_b32 v6, 4, v6
    v_add_u32 v9, v9, v6
    ds_write_b128 v9, v[96:99] offset:0
    ds_write_b128 v9, v[104:107] offset:64
    ds_write_b128 v9, v[112:115] offset:128
    ds_write_b128 v9, v[120:123] offset:192
    ds_write_b128 v9, v[128:131] offset:256
    ds_write_b128 v9, v[136:139] offset:320
    ds_write_b128 v9, v[144:147] offset:384
    ds_write_b128 v9, v[152:155] offset:448
    ds_write_b128 v9, v[160:163] offset:512
    ds_write_b128 v9, v[100:103] offset:9472
    ds_write_b128 v9, v[108:111] offset:9536
    ds_write_b128 v9, v[116:119] offset:9600
    ds_write_b128 v9, v[124:127] offset:9664
    ds_write_b128 v9, v[132:135] offset:9728
    ds_write_b128 v9, v[140:143] offset:9792
    ds_write_b128 v9, v[148:151] offset:9856
    ds_write_b128 v9, v[156:159] offset:9920
    ds_write_b128 v9, v[164:167] offset:9984
    s_waitcnt lgkmcnt(0)
ep_800002:
    s_barrier
    s_mul_i32 s34, s20, 2304
    s_lshl_b32 s35, s21, 2
    s_add_u32 s34, s34, s35
    s_mul_i32 s35, s12, 4718592
    s_add_u32 s34, s34, s35
    v_add_u32 v5, 0, v0
    s_mov_b32 s35, 29128
    v_mul_lo_u32 v6, v5, s35
    v_lshrrev_b32 v6, 20, v6
    v_mul_u32_u24 v7, 36, v6
    v_sub_u32 v7, v5, v7
    v_lshlrev_b32 v7, 4, v7
    v_mul_u32_u24 v5, 592, v6
    v_add_u32 v5, v5, v7
    ds_read_b128 v[40:43], v5
    s_mov_b32 s35, 2304
    v_mul_lo_u32 v6, v6, s35
    v_add_u32 v72, v6, v7
    v_add_u32 v5, 256, v0
    s_mov_b32 s35, 29128
    v_mul_lo_u32 v6, v5, s35
    v_lshrrev_b32 v6, 20, v6
    v_mul_u32_u24 v7, 36, v6
    v_sub_u32 v7, v5, v7
    v_lshlrev_b32 v7, 4, v7
    v_mul_u32_u24 v5, 592, v6
    v_add_u32 v5, v5, v7
    ds_read_b128 v[44:47], v5
    s_mov_b32 s35, 2304
    v_mul_lo_u32 v6, v6, s35
    v_add_u32 v73, v6, v7
    v_add_u32 v5, 512, v0
    s_mov_b32 s35, 29128
    v_mul_lo_u32 v6, v5, s35
    v_lshrrev_b32 v6, 20, v6
    v_mul_u32_u24 v7, 36, v6
    v_sub_u32 v7, v5, v7
    v_lshlrev_b32 v7, 4, v7
    v_mul_u32_u24 v5, 592, v6
    v_add_u32 v5, v5, v7
    ds_read_b128 v[48:51], v5
    s_mov_b32 s35, 2304
    v_mul_lo_u32 v6, v6, s35
    v_add_u32 v74, v6, v7
    v_add_u32 v5, 768, v0
    s_mov_b32 s35, 29128
    v_mul_lo_u32 v6, v5, s35
    v_lshrrev_b32 v6, 20, v6
    v_mul_u32_u24 v7, 36, v6
    v_sub_u32 v7, v5, v7
    v_lshlrev_b32 v7, 4, v7
    v_mul_u32_u24 v5, 592, v6
    v_add_u32 v5, v5, v7
    ds_read_b128 v[52:55], v5
    s_mov_b32 s35, 2304
    v_mul_lo_u32 v6, v6, s35
    v_add_u32 v75, v6, v7
    v_add_u32 v5, 1024, v0
    s_mov_b32 s35, 29128
    v_mul_lo_u32 v6, v5, s35
    v_lshrrev_b32 v6, 20, v6
    v_mul_u32_u24 v7, 36, v6
    v_sub_u32 v7, v5, v7
    v_lshlrev_b32 v7, 4, v7
    v_mul_u32_u24 v5, 592, v6
    v_add_u32 v5, v5, v7
    ds_read_b128 v[56:59], v5
    s_mov_b32 s35, 2304
    v_mul_lo_u32 v6, v6, s35
    v_add_u32 v76, v6, v7
    v_add_u32 v5, 1280, v0
    s_mov_b32 s35, 29128
    v_mul_lo_u32 v6, v5, s35
    v_lshrrev_b32 v6, 20, v6
    v_mul_u32_u24 v7, 36, v6
    v_sub_u32 v7, v5, v7
    v_lshlrev_b32 v7, 4, v7
    v_mul_u32_u24 v5, 592, v6
    v_add_u32 v5, v5, v7
    ds_read_b128 v[60:63], v5
    s_mov_b32 s35, 2304
    v_mul_lo_u32 v6, v6, s35
    v_add_u32 v77, v6, v7
    v_add_u32 v5, 1536, v0
    s_mov_b32 s35, 29128
    v_mul_lo_u32 v6, v5, s35
    v_lshrrev_b32 v6, 20, v6
    v_mul_u32_u24 v7, 36, v6
    v_sub_u32 v7, v5, v7
    v_lshlrev_b32 v7, 4, v7
    v_mul_u32_u24 v5, 592, v6
    v_add_u32 v5, v5, v7
    ds_read_b128 v[64:67], v5
    s_mov_b32 s35, 2304
    v_mul_lo_u32 v6, v6, s35
    v_add_u32 v78, v6, v7
    v_add_u32 v5, 1792, v0
    s_mov_b32 s35, 29128
    v_mul_lo_u32 v6, v5, s35
    v_lshrrev_b32 v6, 20, v6
    v_mul_u32_u24 v7, 36, v6
    v_sub_u32 v7, v5, v7
    v_lshlrev_b32 v7, 4, v7
    v_mul_u32_u24 v5, 592, v6
    v_add_u32 v5, v5, v7
    ds_read_b128 v[68:71], v5
    s_mov_b32 s35, 2304
    v_mul_lo_u32 v6, v6, s35
    v_add_u32 v79, v6, v7
    s_waitcnt lgkmcnt(0)
    buffer_store_dwordx4 v[40:43], v72, s[56:59], s34 offen
    buffer_store_dwordx4 v[44:47], v73, s[56:59], s34 offen
    buffer_store_dwordx4 v[48:51], v74, s[56:59], s34 offen
    buffer_store_dwordx4 v[52:55], v75, s[56:59], s34 offen
    buffer_store_dwordx4 v[56:59], v76, s[56:59], s34 offen
    buffer_store_dwordx4 v[60:63], v77, s[56:59], s34 offen
    buffer_store_dwordx4 v[64:67], v78, s[56:59], s34 offen
    buffer_store_dwordx4 v[68:71], v79, s[56:59], s34 offen
    s_nop 1
    v_add_u32 v5, 2048, v0
    s_mov_b32 s35, 29128
    v_mul_lo_u32 v6, v5, s35
    v_lshrrev_b32 v6, 20, v6
    v_mul_u32_u24 v7, 36, v6
    v_sub_u32 v7, v5, v7
    v_lshlrev_b32 v7, 4, v7
    v_mul_u32_u24 v5, 592, v6
    v_add_u32 v5, v5, v7
    ds_read_b128 v[40:43], v5
    s_mov_b32 s35, 2304
    v_mul_lo_u32 v6, v6, s35
    v_add_u32 v72, v6, v7
    v_add_u32 v5, 2304, v0
    s_mov_b32 s35, 29128
    v_mul_lo_u32 v6, v5, s35
    v_lshrrev_b32 v6, 20, v6
    v_mul_u32_u24 v7, 36, v6
    v_sub_u32 v7, v5, v7
    v_lshlrev_b32 v7, 4, v7
    v_mul_u32_u24 v5, 592, v6
    v_add_u32 v5, v5, v7
    ds_read_b128 v[44:47], v5
    s_mov_b32 s35, 2304
    v_mul_lo_u32 v6, v6, s35
    v_add_u32 v73, v6, v7
    v_add_u32 v5, 2560, v0
    s_mov_b32 s35, 29128
    v_mul_lo_u32 v6, v5, s35
    v_lshrrev_b32 v6, 20, v6
    v_mul_u32_u24 v7, 36, v6
    v_sub_u32 v7, v5, v7
    v_lshlrev_b32 v7, 4, v7
    v_mul_u32_u24 v5, 592, v6
    v_add_u32 v5, v5, v7
    ds_read_b128 v[48:51], v5
    s_mov_b32 s35, 2304
    v_mul_lo_u32 v6, v6, s35
    v_add_u32 v74, v6, v7
    v_add_u32 v5, 2816, v0
    s_mov_b32 s35, 29128
    v_mul_lo_u32 v6, v5, s35
    v_lshrrev_b32 v6, 20, v6
    v_mul_u32_u24 v7, 36, v6
    v_sub_u32 v7, v5, v7
    v_lshlrev_b32 v7, 4, v7
    v_mul_u32_u24 v5, 592, v6
    v_add_u32 v5, v5, v7
    ds_read_b128 v[52:55], v5
    s_mov_b32 s35, 2304
    v_mul_lo_u32 v6, v6, s35
    v_add_u32 v75, v6, v7
    v_add_u32 v5, 3072, v0
    s_mov_b32 s35, 29128
    v_mul_lo_u32 v6, v5, s35
    v_lshrrev_b32 v6, 20, v6
    v_mul_u32_u24 v7, 36, v6
    v_sub_u32 v7, v5, v7
    v_lshlrev_b32 v7, 4, v7
    v_mul_u32_u24 v5, 592, v6
    v_add_u32 v5, v5, v7
    ds_read_b128 v[56:59], v5
    s_mov_b32 s35, 2304
    v_mul_lo_u32 v6, v6, s35
    v_add_u32 v76, v6, v7
    v_add_u32 v5, 3328, v0
    s_mov_b32 s35, 29128
    v_mul_lo_u32 v6, v5, s35
    v_lshrrev_b32 v6, 20, v6
    v_mul_u32_u24 v7, 36, v6
    v_sub_u32 v7, v5, v7
    v_lshlrev_b32 v7, 4, v7
    v_mul_u32_u24 v5, 592, v6
    v_add_u32 v5, v5, v7
    ds_read_b128 v[60:63], v5
    s_mov_b32 s35, 2304
    v_mul_lo_u32 v6, v6, s35
    v_add_u32 v77, v6, v7
    v_add_u32 v5, 3584, v0
    s_mov_b32 s35, 29128
    v_mul_lo_u32 v6, v5, s35
    v_lshrrev_b32 v6, 20, v6
    v_mul_u32_u24 v7, 36, v6
    v_sub_u32 v7, v5, v7
    v_lshlrev_b32 v7, 4, v7
    v_mul_u32_u24 v5, 592, v6
    v_add_u32 v5, v5, v7
    ds_read_b128 v[64:67], v5
    s_mov_b32 s35, 2304
    v_mul_lo_u32 v6, v6, s35
    v_add_u32 v78, v6, v7
    v_add_u32 v5, 3840, v0
    s_mov_b32 s35, 29128
    v_mul_lo_u32 v6, v5, s35
    v_lshrrev_b32 v6, 20, v6
    v_mul_u32_u24 v7, 36, v6
    v_sub_u32 v7, v5, v7
    v_lshlrev_b32 v7, 4, v7
    v_mul_u32_u24 v5, 592, v6
    v_add_u32 v5, v5, v7
    ds_read_b128 v[68:71], v5
    s_mov_b32 s35, 2304
    v_mul_lo_u32 v6, v6, s35
    v_add_u32 v79, v6, v7
    s_waitcnt lgkmcnt(0)
    buffer_store_dwordx4 v[40:43], v72, s[56:59], s34 offen
    buffer_store_dwordx4 v[44:47], v73, s[56:59], s34 offen
    buffer_store_dwordx4 v[48:51], v74, s[56:59], s34 offen
    buffer_store_dwordx4 v[52:55], v75, s[56:59], s34 offen
    buffer_store_dwordx4 v[56:59], v76, s[56:59], s34 offen
    buffer_store_dwordx4 v[60:63], v77, s[56:59], s34 offen
    buffer_store_dwordx4 v[64:67], v78, s[56:59], s34 offen
    buffer_store_dwordx4 v[68:71], v79, s[56:59], s34 offen
    s_nop 1
    v_add_u32 v5, 4096, v0
    s_mov_b32 s35, 29128
    v_mul_lo_u32 v6, v5, s35
    v_lshrrev_b32 v6, 20, v6
    v_mul_u32_u24 v7, 36, v6
    v_sub_u32 v7, v5, v7
    v_lshlrev_b32 v7, 4, v7
    v_mul_u32_u24 v5, 592, v6
    v_add_u32 v5, v5, v7
    ds_read_b128 v[40:43], v5
    s_mov_b32 s35, 2304
    v_mul_lo_u32 v6, v6, s35
    v_add_u32 v72, v6, v7
    v_add_u32 v5, 4352, v0
    s_mov_b32 s35, 29128
    v_mul_lo_u32 v6, v5, s35
    v_lshrrev_b32 v6, 20, v6
    v_mul_u32_u24 v7, 36, v6
    v_sub_u32 v7, v5, v7
    v_lshlrev_b32 v7, 4, v7
    v_mul_u32_u24 v5, 592, v6
    v_add_u32 v5, v5, v7
    ds_read_b128 v[44:47], v5
    s_mov_b32 s35, 2304
    v_mul_lo_u32 v6, v6, s35
    v_add_u32 v73, v6, v7
    s_waitcnt lgkmcnt(0)
    buffer_store_dwordx4 v[40:43], v72, s[56:59], s34 offen
    buffer_store_dwordx4 v[44:47], v73, s[56:59], s34 offen
    s_nop 1
k5_end:
    s_endpgm

.globl k6_kernel
.p2align 8
.type k6_kernel,@function
k6_kernel:
    s_cmp_ge_u32 s2, 1152
    s_cbranch_scc1 k6_end
    s_load_dwordx2 s[6:7], s[0:1], 72
    s_load_dwordx2 s[8:9], s[0:1], 88
    s_waitcnt lgkmcnt(0)
    s_mov_b32 s12, s6
    s_mov_b32 s13, s7
    s_and_b32 s13, s13, 0xffff
    s_mov_b32 s14, 0x240000
    s_mov_b32 s15, 0x00020000
    s_add_u32 s16, s8, 0x2800000
    s_addc_u32 s17, s9, 0
    s_and_b32 s17, s17, 0xffff
    s_mov_b32 s18, 0x1200000
    s_mov_b32 s19, 0x00020000
    s_add_u32 s20, s8, 0x1000000
    s_addc_u32 s21, s9, 0
    s_and_b32 s21, s21, 0xffff
    s_mov_b32 s22, 0x240000
    s_mov_b32 s23, 0x00020000
    s_mov_b32 s24, s8
    s_mov_b32 s25, s9
    s_and_b32 s25, s25, 0xffff
    s_mov_b32 s26, 0x4000
    s_mov_b32 s27, 0x00020000
    s_lshl_b32 s3, s2, 8
    v_add_u32 v1, s3, v0
    v_lshlrev_b32 v2, 4, v1
    v_lshlrev_b32 v3, 3, v1
    s_mov_b32 s4, 144
    s_mov_b32 s5, 29826162
    v_mul_hi_u32 v4, v1, s5
    v_mul_u32_u24 v4, 144, v4
    v_sub_u32 v4, v1, v4
    v_lshlrev_b32 v4, 4, v4
    v_add_u32 v4, 11520, v4
    s_mov_b32 s6, 0
    buffer_load_dwordx4 v[8:11], v2, s[16:19], s6 offen
    s_mov_b32 s6, 4718592
    buffer_load_dwordx4 v[12:15], v2, s[16:19], s6 offen
    s_mov_b32 s6, 9437184
    buffer_load_dwordx4 v[16:19], v2, s[16:19], s6 offen
    s_mov_b32 s6, 14155776
    buffer_load_dwordx4 v[20:23], v2, s[16:19], s6 offen
    buffer_load_dwordx2 v[24:25], v3, s[20:23], 0 offen
    buffer_load_dwordx4 v[28:31], v4, s[24:27], 0 offen
    s_waitcnt vmcnt(0)
    v_add_f32 v8, v8, v12
    v_add_f32 v16, v16, v20
    v_add_f32 v8, v8, v16
    v_add_f32 v9, v9, v13
    v_add_f32 v17, v17, v21
    v_add_f32 v9, v9, v17
    v_add_f32 v10, v10, v14
    v_add_f32 v18, v18, v22
    v_add_f32 v10, v10, v18
    v_add_f32 v11, v11, v15
    v_add_f32 v19, v19, v23
    v_add_f32 v11, v11, v19
    v_lshlrev_b32 v12, 16, v24
    v_and_b32 v13, 0xffff0000, v24
    v_lshlrev_b32 v14, 16, v25
    v_and_b32 v15, 0xffff0000, v25
    v_fma_f32 v8, v8, v28, v12
    v_fma_f32 v9, v9, v29, v13
    v_fma_f32 v10, v10, v30, v14
    v_fma_f32 v11, v11, v31, v15
    v_cvt_pk_bf16_f32 v8, v8, v9
    v_cvt_pk_bf16_f32 v9, v10, v11
    buffer_store_dwordx2 v[8:9], v3, s[12:15], 0 offen
k6_end:
    s_endpgm

.section .rodata,"a"
.p2align 6
.amdhsa_kernel k0_kernel
  .amdhsa_next_free_vgpr 64
  .amdhsa_next_free_sgpr 102
  .amdhsa_accum_offset 64
  .amdhsa_group_segment_fixed_size 0
  .amdhsa_kernarg_size 96
  .amdhsa_user_sgpr_count 2
  .amdhsa_user_sgpr_kernarg_segment_ptr 1
  .amdhsa_system_sgpr_workgroup_id_x 1
.end_amdhsa_kernel

.p2align 6
.amdhsa_kernel ln1_kernel
  .amdhsa_next_free_vgpr 64
  .amdhsa_next_free_sgpr 102
  .amdhsa_accum_offset 64
  .amdhsa_group_segment_fixed_size 0
  .amdhsa_kernarg_size 96
  .amdhsa_user_sgpr_count 2
  .amdhsa_user_sgpr_kernarg_segment_ptr 1
  .amdhsa_system_sgpr_workgroup_id_x 1
.end_amdhsa_kernel

.p2align 6
.amdhsa_kernel k1_kernel
  .amdhsa_next_free_vgpr 168
  .amdhsa_next_free_sgpr 102
  .amdhsa_accum_offset 168
  .amdhsa_group_segment_fixed_size 0
  .amdhsa_kernarg_size 96
  .amdhsa_user_sgpr_count 2
  .amdhsa_user_sgpr_kernarg_segment_ptr 1
  .amdhsa_system_sgpr_workgroup_id_x 1
.end_amdhsa_kernel

.p2align 6
.amdhsa_kernel k2_kernel
  .amdhsa_next_free_vgpr 144
  .amdhsa_next_free_sgpr 102
  .amdhsa_accum_offset 144
  .amdhsa_group_segment_fixed_size 0
  .amdhsa_kernarg_size 96
  .amdhsa_user_sgpr_count 2
  .amdhsa_user_sgpr_kernarg_segment_ptr 1
  .amdhsa_system_sgpr_workgroup_id_x 1
.end_amdhsa_kernel

.p2align 6
.amdhsa_kernel k3_kernel
  .amdhsa_next_free_vgpr 224
  .amdhsa_next_free_sgpr 102
  .amdhsa_accum_offset 224
  .amdhsa_group_segment_fixed_size 0
  .amdhsa_kernarg_size 96
  .amdhsa_user_sgpr_count 2
  .amdhsa_user_sgpr_kernarg_segment_ptr 1
  .amdhsa_system_sgpr_workgroup_id_x 1
.end_amdhsa_kernel

.p2align 6
.amdhsa_kernel ln2_kernel
  .amdhsa_next_free_vgpr 64
  .amdhsa_next_free_sgpr 102
  .amdhsa_accum_offset 64
  .amdhsa_group_segment_fixed_size 0
  .amdhsa_kernarg_size 96
  .amdhsa_user_sgpr_count 2
  .amdhsa_user_sgpr_kernarg_segment_ptr 1
  .amdhsa_system_sgpr_workgroup_id_x 1
.end_amdhsa_kernel

.p2align 6
.amdhsa_kernel k4_kernel
  .amdhsa_next_free_vgpr 512
  .amdhsa_next_free_sgpr 102
  .amdhsa_accum_offset 256
  .amdhsa_group_segment_fixed_size 0
  .amdhsa_kernarg_size 96
  .amdhsa_user_sgpr_count 2
  .amdhsa_user_sgpr_kernarg_segment_ptr 1
  .amdhsa_system_sgpr_workgroup_id_x 1
.end_amdhsa_kernel

.p2align 6
.amdhsa_kernel k5_kernel
  .amdhsa_next_free_vgpr 168
  .amdhsa_next_free_sgpr 102
  .amdhsa_accum_offset 168
  .amdhsa_group_segment_fixed_size 0
  .amdhsa_kernarg_size 96
  .amdhsa_user_sgpr_count 2
  .amdhsa_user_sgpr_kernarg_segment_ptr 1
  .amdhsa_system_sgpr_workgroup_id_x 1
.end_amdhsa_kernel

.p2align 6
.amdhsa_kernel k6_kernel
  .amdhsa_next_free_vgpr 32
  .amdhsa_next_free_sgpr 102
  .amdhsa_accum_offset 32
  .amdhsa_group_segment_fixed_size 0
  .amdhsa_kernarg_size 96
  .amdhsa_user_sgpr_count 2
  .amdhsa_user_sgpr_kernarg_segment_ptr 1
  .amdhsa_system_sgpr_workgroup_id_x 1
.end_amdhsa_kernel
```
